```python
import torch

def _softmax(x, axis=-1):
    return torch.softmax(x, dim=axis)
def _gelu(x):
    return torch.nn.functional.gelu(x, approximate="tanh")
def _silu(x):
    return torch.nn.functional.silu(x)
def _sigmoid(x):
    return torch.sigmoid(x)
def _layernorm(x, axis=-1, eps=1e-5):
    m = x.mean(dim=axis, keepdim=True)
    v = x.var(dim=axis, keepdim=True, unbiased=False)
    return (x - m) / torch.sqrt(v + eps)
def _scatter_add(tgt, idx, src, axis=0):
    return tgt.clone().index_add_(axis, idx, src)
def _segment_sum(src, seg, n):
    out = torch.zeros((n,) + src.shape[1:], dtype=src.dtype)
    return out.index_add_(0, seg, src)
def _pad(x, pw):
    flat = tuple(v for pair in reversed(pw) for v in pair)
    return torch.nn.functional.pad(x, flat)

kernel_name = 'gated_mix__spectral_fnet__dense_activation_relu__prompt'

def setup_inputs():

    _w = (lambda a: (lambda t: t.to(torch.bfloat16) if t.is_floating_point() else t)(torch.as_tensor(a)))
    def _A_setup():
        B, S, D = 1, 2048, 576
        ns = torch.arange(S)[:, None] * torch.arange(S)[None, :]
        nd = torch.arange(D)[:, None] * torch.arange(D)[None, :]
        Ws_re = torch.cos(-2.0 * torch.pi * ns / S).to(float)
        Ws_im = torch.sin(-2.0 * torch.pi * ns / S).to(float)
        Wd_re = torch.cos(-2.0 * torch.pi * nd / D).to(float)
        Wd_im = torch.sin(-2.0 * torch.pi * nd / D).to(float)
        return {
            "x": _w((lambda *s: torch.randn(*s, dtype=torch.bfloat16) * 0.05)(B, S, D)),
            "dft_seq_re": _w(Ws_re),
            "dft_seq_im": _w(Ws_im),
            "dft_hid_re": _w(Wd_re),
            "dft_hid_im": _w(Wd_im),
        }
    _A_in = _A_setup()

    def _B_setup():
        B, S, D, Dff = 1, 2048, 576, 4608
        return {
            "x": _w((lambda *s: torch.randn(*s, dtype=torch.bfloat16) * 0.05)(B, S, D)),
            "w1": _w((lambda *s: torch.randn(*s, dtype=torch.bfloat16) * 0.4)(D, Dff)),
            "w2": _w((lambda *s: torch.randn(*s, dtype=torch.bfloat16) * 0.4)(Dff, D)),
        }
    _B_in = _B_setup()

    return {
        "A_x": _A_in["x"],
        "A_dft_seq_re": _A_in["dft_seq_re"],
        "A_dft_seq_im": _A_in["dft_seq_im"],
        "A_dft_hid_re": _A_in["dft_hid_re"],
        "A_dft_hid_im": _A_in["dft_hid_im"],
        "B_x": _B_in["x"],
        "B_w1": _B_in["w1"],
        "B_w2": _B_in["w2"],
        "gate_w": _w((lambda *s: torch.randn(*s, dtype=torch.bfloat16) * 0.05)(576) * 16.0),
    }

def reference(A_x, A_dft_seq_re, A_dft_seq_im, A_dft_hid_re, A_dft_hid_im, B_x, B_w1, B_w2, gate_w):
    def _A_ref(x, dft_seq_re, dft_seq_im, dft_hid_re, dft_hid_im):
        a = torch.einsum("bsd,ed->bse", x, dft_hid_re)
        b = torch.einsum("bsd,ed->bse", x, dft_hid_im)
        y = torch.einsum("ts,bse->bte", dft_seq_re, a) - torch.einsum("ts,bse->bte", dft_seq_im, b)
        return y

    def _B_ref(x, w1, w2):
        h = torch.einsum("bsd,df->bsf", x, w1)
        zero = torch.zeros_like(h)
        h = torch.maximum(h, zero)
        return torch.einsum("bsf,fd->bsd", h, w2)

    x = A_x
    g = _sigmoid((x * gate_w).sum(-1, keepdims=True))
    a = _A_ref(x, A_dft_seq_re, A_dft_seq_im, A_dft_hid_re, A_dft_hid_im)
    b = _B_ref(x, B_w1, B_w2)
    return g * a + (1 - g) * b
```

```asm
; @launch grid=(256,1,1) block=(512,1,1) lds=163840
.amdgcn_target "amdgcn-amd-amdhsa--gfx950"
.text
.globl gated_mix__spectral_fnet__dense_activation_relu__prompt_kernel
    .p2align 8
    .type gated_mix__spectral_fnet__dense_activation_relu__prompt_kernel,@function
gated_mix__spectral_fnet__dense_activation_relu__prompt_kernel:
    s_cmp_ge_u32 s2, 256
    s_cbranch_scc1 K_END
    s_load_dwordx2 s[44:45], s[0:1], 0
    s_load_dwordx4 s[52:55], s[0:1], 48
    s_load_dwordx8 s[56:63], s[0:1], 64
    s_getpc_b64 s[16:17]
IWP:
    s_sub_u32 s16, s16, IWP-gated_mix__spectral_fnet__dense_activation_relu__prompt_kernel
    s_subb_u32 s17, s17, 0
    s_andn2_b32 s18, s2, 7
    s_lshl_b32 s18, s18, 7
    v_lshl_add_u32 v3, v0, 1, s18
    v_min_u32 v3, K_END-gated_mix__spectral_fnet__dense_activation_relu__prompt_kernel, v3
    s_mov_b64 exec, 1
    global_load_dword v15, v3, s[16:17]
    s_mov_b64 exec, -1
    s_mov_b32 s99, 0
    v_lshrrev_b32 v1, 6, v0
    s_and_b32 s3, s2, 7
    s_lshr_b32 s4, s2, 3
    v_readfirstlane_b32 s5, v1
    v_and_b32 v0, 63, v0
    s_mul_i32 s6, s4, 57
    s_lshr_b32 s6, s6, 9
    s_and_b32 s98, s6, 1
    s_mul_i32 s6, s6, 9
    s_sub_u32 s6, s4, s6
    s_add_u32 s6, s6, s3
    s_sub_u32 s7, s6, 9
    s_cmp_ge_u32 s6, 9
    s_cselect_b32 s6, s7, s6
    s_add_u32 s15, s3, s4
    s_and_b32 s15, s15, 7
    s_cmp_ge_u32 s5, 6
    s_cbranch_scc1 K_AUX
    s_cmp_ge_u32 s5, 4
    s_cbranch_scc0 K_MAIN
    s_setprio 3
    s_sub_u32 s7, s5, 4
    v_lshrrev_b32 v1, 3, v0
    v_and_b32 v2, 7, v0
    v_lshrrev_b32 v4, 1, v2
    v_and_b32 v5, 1, v2
    v_lshlrev_b32 v5, 4, v5
    s_movk_i32 s16, 8064
    v_add_u32 v6, 0, v1
    v_mul_u32_u24 v7, 57, v6
    v_lshrrev_b32 v7, 9, v7
    v_bfe_u32 v9, v7, 1, 1
    v_xor_b32 v9, v9, v4
    v_lshl_add_u32 v6, v6, 7, v5
    v_mad_u32_u24 v6, v7, s16, v6
    v_lshl_add_u32 v6, v9, 5, v6
    v_xor_b32 v7, 64, v6
    v_subrev_u32 v16, 0, v6
    v_add_u32 v25, 72704, v7
    v_add_u32 v6, 8, v1
    v_mul_u32_u24 v7, 57, v6
    v_lshrrev_b32 v7, 9, v7
    v_bfe_u32 v9, v7, 1, 1
    v_xor_b32 v9, v9, v4
    v_lshl_add_u32 v6, v6, 7, v5
    v_mad_u32_u24 v6, v7, s16, v6
    v_lshl_add_u32 v6, v9, 5, v6
    v_xor_b32 v7, 64, v6
    v_subrev_u32 v17, 1024, v6
    v_add_u32 v26, 71680, v7
    v_add_u32 v6, 16, v1
    v_mul_u32_u24 v7, 57, v6
    v_lshrrev_b32 v7, 9, v7
    v_bfe_u32 v9, v7, 1, 1
    v_xor_b32 v9, v9, v4
    v_lshl_add_u32 v6, v6, 7, v5
    v_mad_u32_u24 v6, v7, s16, v6
    v_lshl_add_u32 v6, v9, 5, v6
    v_xor_b32 v7, 64, v6
    v_subrev_u32 v18, 2048, v6
    v_add_u32 v27, 70656, v7
    v_add_u32 v6, 24, v1
    v_mul_u32_u24 v7, 57, v6
    v_lshrrev_b32 v7, 9, v7
    v_bfe_u32 v9, v7, 1, 1
    v_xor_b32 v9, v9, v4
    v_lshl_add_u32 v6, v6, 7, v5
    v_mad_u32_u24 v6, v7, s16, v6
    v_lshl_add_u32 v6, v9, 5, v6
    v_xor_b32 v7, 64, v6
    v_subrev_u32 v19, 3072, v6
    v_add_u32 v28, 73728, v7
    v_add_u32 v6, 32, v1
    v_mul_u32_u24 v7, 57, v6
    v_lshrrev_b32 v7, 9, v7
    v_bfe_u32 v9, v7, 1, 1
    v_xor_b32 v9, v9, v4
    v_lshl_add_u32 v6, v6, 7, v5
    v_mad_u32_u24 v6, v7, s16, v6
    v_lshl_add_u32 v6, v9, 5, v6
    v_xor_b32 v7, 64, v6
    v_subrev_u32 v20, 0, v6
    v_add_u32 v29, 72704, v7
    v_add_u32 v6, 40, v1
    v_mul_u32_u24 v7, 57, v6
    v_lshrrev_b32 v7, 9, v7
    v_bfe_u32 v9, v7, 1, 1
    v_xor_b32 v9, v9, v4
    v_lshl_add_u32 v6, v6, 7, v5
    v_mad_u32_u24 v6, v7, s16, v6
    v_lshl_add_u32 v6, v9, 5, v6
    v_xor_b32 v7, 64, v6
    v_subrev_u32 v21, 1024, v6
    v_add_u32 v30, 71680, v7
    v_add_u32 v6, 48, v1
    v_mul_u32_u24 v7, 57, v6
    v_lshrrev_b32 v7, 9, v7
    v_bfe_u32 v9, v7, 1, 1
    v_xor_b32 v9, v9, v4
    v_lshl_add_u32 v6, v6, 7, v5
    v_mad_u32_u24 v6, v7, s16, v6
    v_lshl_add_u32 v6, v9, 5, v6
    v_xor_b32 v7, 64, v6
    v_subrev_u32 v22, 2048, v6
    v_add_u32 v31, 70656, v7
    v_add_u32 v6, 56, v1
    v_mul_u32_u24 v7, 57, v6
    v_lshrrev_b32 v7, 9, v7
    v_bfe_u32 v9, v7, 1, 1
    v_xor_b32 v9, v9, v4
    v_lshl_add_u32 v6, v6, 7, v5
    v_mad_u32_u24 v6, v7, s16, v6
    v_lshl_add_u32 v6, v9, 5, v6
    v_xor_b32 v7, 64, v6
    v_subrev_u32 v23, 3072, v6
    v_add_u32 v32, 73728, v7
    v_add_u32 v6, 64, v1
    v_mul_u32_u24 v7, 57, v6
    v_lshrrev_b32 v7, 9, v7
    v_bfe_u32 v9, v7, 1, 1
    v_xor_b32 v9, v9, v4
    v_lshl_add_u32 v6, v6, 7, v5
    v_mad_u32_u24 v6, v7, s16, v6
    v_lshl_add_u32 v6, v9, 5, v6
    v_xor_b32 v7, 64, v6
    v_subrev_u32 v24, 0, v6
    v_add_u32 v33, 72704, v7
    v_lshrrev_b32 v6, 1, v1
    v_and_b32 v6, 3, v6
    v_lshlrev_b32 v6, 1, v6
    v_xor_b32 v6, v6, v2
    s_movk_i32 s69, 1152
    v_mul_u32_u24 v7, s69, v1
    v_lshl_add_u32 v36, v6, 4, v7
    v_add_u32 v37, 8192, v36
    v_add_u32 v38, 16384, v36
    v_add_u32 v39, 24576, v36
    s_mul_i32 s64, s7, 18432
    s_mul_i32 s17, s3, 1152
    s_mul_i32 s18, s7, 147456
    s_add_u32 s17, s17, s18
    s_lshl_b32 s18, s6, 1
    s_xor_b32 s66, s18, s98
    s_mul_i32 s66, s66, 294912
    s_add_u32 s66, s66, s17
    s_mov_b32 s67, s64
    s_mov_b32 s68, 0
    s_mov_b32 s69, -2
    s_mul_i32 s70, s3, 576
    s_mul_i32 s71, s7, 144
    s_add_u32 s70, s70, s71
    s_mul_i32 s70, s70, 1152
    s_lshl_b32 s19, s7, 8
    s_add_u32 s19, s19, 155648
    v_lshlrev_b32 v11, 2, v0
    v_add_u32 v11, s19, v11
    v_mov_b32 v10, 0
    v_mov_b32 v13, 0
    v_mov_b32 v40, 0
    v_mov_b32 v41, 0
    v_and_b32 v12, 3, v0
    v_mul_u32_u24 v12, 260, v12
    v_add_u32 v12, 156672, v12
    s_waitcnt lgkmcnt(0)
    s_mov_b32 s20, s52
    s_mov_b32 s21, s53
    s_mov_b32 s22, 5308416
    s_mov_b32 s23, 0x20000
    s_mov_b32 s24, s54
    s_mov_b32 s25, s55
    s_mov_b32 s26, 5308416
    s_mov_b32 s27, 0x20000
    s_setprio 3
LD_P:
    s_mov_b32 m0, s67
    s_nop 0
    buffer_load_dwordx4 v16, s[20:23], s66 offen offset:0 lds
    s_add_u32 s18, s18, 1
    buffer_load_dwordx4 v17, s[20:23], s66 offen offset:1024 lds
    s_cmp_eq_u32 s18, 18
    s_cselect_b32 s18, 0, s18
    buffer_load_dwordx4 v18, s[20:23], s66 offen offset:2048 lds
    s_xor_b32 s44, s18, s98
    buffer_load_dwordx4 v19, s[20:23], s66 offen offset:3072 lds
    s_mul_i32 s44, s44, 294912
    s_add_u32 m0, s67, 4096
    s_nop 0
    buffer_load_dwordx4 v20, s[20:23], s66 offen offset:0 lds
    s_add_u32 s44, s44, s17
    buffer_load_dwordx4 v21, s[20:23], s66 offen offset:1024 lds
    s_add_u32 s45, s67, 36864
    buffer_load_dwordx4 v22, s[20:23], s66 offen offset:2048 lds
    s_cmp_ge_u32 s45, 110592
    s_cselect_b32 s45, s64, s45
    buffer_load_dwordx4 v23, s[20:23], s66 offen offset:3072 lds
    s_add_u32 m0, s67, 8192
    s_nop 0
    buffer_load_dwordx4 v24, s[20:23], s66 offen offset:0 lds
    buffer_load_dwordx4 v25, s[20:23], s66 offen offset:1024 lds
    buffer_load_dwordx4 v26, s[20:23], s66 offen offset:2048 lds
    buffer_load_dwordx4 v27, s[20:23], s66 offen offset:3072 lds
    s_add_u32 m0, s67, 12288
    s_nop 0
    buffer_load_dwordx4 v28, s[20:23], s66 offen offset:0 lds
    buffer_load_dwordx4 v29, s[20:23], s66 offen offset:1024 lds
    buffer_load_dwordx4 v30, s[20:23], s66 offen offset:2048 lds
    buffer_load_dwordx4 v31, s[20:23], s66 offen offset:3072 lds
    s_cmp_le_u32 s68, 0
    s_cbranch_scc1 LD_P0
    s_waitcnt vmcnt(16)
    s_barrier
LD_P0:
    s_add_u32 m0, s67, 16384
    s_nop 0
    buffer_load_dwordx4 v32, s[20:23], s66 offen offset:0 lds
    buffer_load_dwordx4 v33, s[20:23], s66 offen offset:1024 lds
    s_mov_b32 s66, s44
    s_mov_b32 s67, s45
    s_add_u32 s68, s68, 1
    s_cmp_lt_u32 s68, 18
    s_cbranch_scc1 LD_P
    s_add_u32 s66, s70, 1024
    s_mov_b32 s69, 0
    s_setprio 0
LD_Q:
    s_waitcnt lgkmcnt(1)
    v_cmp_gt_u32 vcc, s69, v13
    s_mov_b32 m0, s67
    s_cbranch_vccnz LD_QS
LD_QR:
    buffer_load_dwordx4 v36, s[24:27], s66 offen offset:0 lds
    s_sub_u32 s46, s68, 17
    buffer_load_dwordx4 v37, s[24:27], s66 offen offset:1024 lds
    s_lshr_b32 s44, s46, 1
    buffer_load_dwordx4 v38, s[24:27], s66 offen offset:2048 lds
    s_add_u32 s47, s44, s15
    buffer_load_dwordx4 v39, s[24:27], s66 offen offset:3072 lds
    s_and_b32 s47, s47, 7
    s_add_u32 m0, s67, 4096
    s_add_u32 s66, s66, 36864
    buffer_load_dwordx4 v36, s[24:27], s66 offen offset:0 lds
    s_cmp_eq_u32 s44, 0
    s_cselect_b32 s47, 8, s47
    buffer_load_dwordx4 v37, s[24:27], s66 offen offset:1024 lds
    s_lshl_b32 s47, s47, 7
    buffer_load_dwordx4 v38, s[24:27], s66 offen offset:2048 lds
    s_and_b32 s44, s46, 1
    buffer_load_dwordx4 v39, s[24:27], s66 offen offset:3072 lds
    s_mul_i32 s44, s44, 331776
    s_add_u32 m0, s67, 8192
    s_add_u32 s66, s66, 36864
    buffer_load_dwordx4 v36, s[24:27], s66 offen offset:0 lds
    s_add_u32 s44, s44, s47
    buffer_load_dwordx4 v37, s[24:27], s66 offen offset:1024 lds
    s_add_u32 s44, s44, s70
    buffer_load_dwordx4 v38, s[24:27], s66 offen offset:2048 lds
    s_add_u32 s45, s67, 36864
    buffer_load_dwordx4 v39, s[24:27], s66 offen offset:3072 lds
    s_cmp_ge_u32 s45, 147456
    s_cselect_b32 s45, s64, s45
    s_add_u32 m0, s67, 12288
    s_add_u32 s66, s66, 36864
    buffer_load_dwordx4 v36, s[24:27], s66 offen offset:0 lds
    s_cmp_le_u32 s68, 20
    s_cselect_b32 s69, 0, s68
    buffer_load_dwordx4 v37, s[24:27], s66 offen offset:1024 lds
    buffer_load_dwordx4 v38, s[24:27], s66 offen offset:2048 lds
    buffer_load_dwordx4 v39, s[24:27], s66 offen offset:3072 lds
    v_mov_b32 v10, s68
    s_waitcnt vmcnt(16)
    s_cmp_eq_u32 s68, 18
    s_cbranch_scc0 LD_Q0
    s_barrier
LD_Q0:
    ds_read_b32 v13, v12
    ds_write_b32 v11, v10
    s_add_u32 m0, s67, 16384
    s_add_u32 s66, s66, 36864
    buffer_load_dwordx4 v36, s[24:27], s66 offen offset:0 lds
    buffer_load_dwordx4 v37, s[24:27], s66 offen offset:1024 lds
    s_mov_b32 s66, s44
    s_mov_b32 s67, s45
    s_add_u32 s68, s68, 1
    s_cmp_le_u32 s68, 20
    s_cbranch_scc1 LD_E
    s_cmp_lt_u32 s68, 36
    s_cbranch_scc1 LD_Q
    v_mov_b32 v10, s68
    s_waitcnt vmcnt(0)
    ds_write_b32 v11, v10
    s_waitcnt lgkmcnt(0)
    s_endpgm
LD_E:
    s_barrier
    s_cmp_eq_u32 s68, 20
    s_cbranch_scc1 LD_Q
    v_mov_b32 v10, s68
    s_waitcnt vmcnt(0)
    ds_write_b32 v11, v10
    s_waitcnt lgkmcnt(0)
    s_barrier
    s_branch LD_Q
LD_QS:
    ds_read_b32 v13, v12
    s_waitcnt lgkmcnt(0)
    v_cmp_gt_u32 vcc, s69, v13
    s_cbranch_vccz LD_QR
    v_mov_b32 v10, s68
    s_waitcnt vmcnt(0)
    ds_write_b32 v11, v10
W1:
    ds_read_b32 v13, v12
    s_add_u32 s99, s99, 1
    s_cmp_gt_u32 s99, 0x100000
    s_cbranch_scc1 K_END
    s_waitcnt lgkmcnt(0)
    v_cmp_gt_u32 vcc, s69, v13
    s_cbranch_vccnz W1
    s_branch LD_QR
K_AUX:
    s_setprio 2
    s_sub_u32 s7, s5, 6
    v_lshrrev_b32 v1, 3, v0
    v_and_b32 v2, 7, v0
    v_lshrrev_b32 v3, 1, v1
    v_xor_b32 v4, v2, v3
    v_lshlrev_b32 v4, 4, v4
    v_xor_b32 v5, 64, v4
    s_mov_b32 s16, 73728
    v_mul_u32_u24 v6, s16, v1
    v_add_u32 v16, v6, v4
    v_add_u32 v17, v6, v5
    v_add_u32 v17, 588800, v17
    v_add_u32 v18, v6, v4
    v_add_u32 v18, 1177600, v18
    v_add_u32 v19, v6, v5
    v_add_u32 v19, 1766400, v19
    v_lshlrev_b32 v25, 4, v0
    s_movk_i32 s17, 1152
    v_and_b32 v8, 31, v0
    v_mul_u32_u24 v7, 57, v8
    v_lshrrev_b32 v62, 9, v7
    v_mul_u32_u24 v7, 9, v62
    v_sub_u32 v7, v8, v7
    v_mul_u32_u24 v24, s17, v7
    v_lshrrev_b32 v7, 5, v0
    v_lshl_add_u32 v24, v7, 6, v24
    s_lshl_b32 s18, s7, 5
    s_add_u32 s18, s18, s4
    s_mul_i32 s18, s18, 1152
    s_mul_i32 s19, s3, 576
    s_mul_i32 s64, s4, 18
    s_add_u32 s19, s19, s64
    s_mul_i32 s64, s7, 9
    s_add_u32 s19, s19, s64
    s_mul_i32 s19, s19, 1152
    s_mov_b32 s64, s6
    s_lshl_b32 s69, s7, 12
    s_lshl_b32 s70, s7, 10
    s_add_u32 s65, s69, 110592
    s_waitcnt lgkmcnt(0)
    s_mov_b32 s8, s44
    s_mov_b32 s9, s45
    s_mov_b32 s10, 2359296
    s_mov_b32 s11, 0x20000
    s_mov_b32 s28, s56
    s_mov_b32 s29, s57
    s_mov_b32 s30, 1152
    s_mov_b32 s31, 0x20000
    s_lshl_b32 s67, s64, 7
    s_add_u32 s67, s67, s18
    s_mov_b32 m0, s65
    s_nop 0
    buffer_load_dwordx4 v16, s[8:11], s67 offen offset:0 lds
    buffer_load_dwordx4 v17, s[8:11], s67 offen offset:1024 lds
    s_mov_b32 m0, s65
    s_nop 0
    buffer_load_dwordx4 v18, s[8:11], s67 offen offset:2048 lds
    buffer_load_dwordx4 v19, s[8:11], s67 offen offset:3072 lds
    s_add_u32 s64, s64, 1
    s_cmp_eq_u32 s64, 9
    s_cselect_b32 s64, 0, s64
    s_add_u32 s65, s65, 8192
    s_sub_u32 s66, s65, 32768
    s_cmp_ge_u32 s65, 143360
    s_cselect_b32 s65, s66, s65
    s_add_u32 m0, s70, 158720
    s_cmp_eq_u32 s7, 0
    s_cselect_b32 exec_lo, -1, 0xff
    s_cselect_b32 exec_hi, -1, 0
    buffer_load_dwordx4 v25, s[28:31], s70 offen lds
    s_mov_b64 exec, -1
    s_mov_b32 s24, s54
    s_mov_b32 s25, s55
    s_mov_b32 s26, 5308416
    s_mov_b32 s27, 0x20000
    s_mov_b32 s32, s62
    s_mov_b32 s33, s63
    s_mov_b32 s34, 28311552
    s_mov_b32 s35, 0x20000
    s_mov_b32 s36, s58
    s_mov_b32 s37, s59
    s_mov_b32 s38, 2359296
    s_mov_b32 s39, 0x20000
    s_mov_b32 s40, s60
    s_mov_b32 s41, s61
    s_mov_b32 s42, 256
    s_mov_b32 s43, 0x20000
    v_and_b32 v8, 15, v0
    v_lshrrev_b32 v9, 4, v0
    v_mov_b32 v231, 0
    s_lshl_b32 s71, s2, 1
    s_add_u32 s71, s71, s7
    s_lshl_b32 s71, s71, 2
    s_add_u32 s71, s71, 25231360
    s_or_b32 s14, s4, s7
    s_cmp_eq_u32 s14, 0
    s_cbranch_scc0 AX_NZ
    v_mov_b32 v56, 0
    v_mov_b32 v57, 0
    v_mov_b32 v58, 0
    v_mov_b32 v59, 0
    s_lshl_b32 s48, s3, 12
    s_add_u32 s48, s48, 25165824
    s_lshl_b32 s49, s3, 8
    s_add_u32 s49, s49, 25231360
    buffer_store_dwordx4 v[56:59], v25, s[32:35], s48 offen offset:0 sc1
    buffer_store_dwordx4 v[56:59], v25, s[32:35], s48 offen offset:1024 sc1
    buffer_store_dwordx4 v[56:59], v25, s[32:35], s48 offen offset:2048 sc1
    buffer_store_dwordx4 v[56:59], v25, s[32:35], s48 offen offset:3072 sc1
    s_mov_b64 exec, 0xffff
    buffer_store_dwordx4 v[56:59], v25, s[32:35], s49 offen sc1
    s_mov_b64 exec, -1
AX_NZ:
    v_and_b32 v63, 7, v0
    v_lshlrev_b32 v63, 2, v63
    v_mov_b32 v254, 0
    v_lshrrev_b32 v10, 1, v8
    v_xor_b32 v10, v10, v9
    v_lshlrev_b32 v10, 4, v10
    v_lshl_add_u32 v20, v8, 7, v10
    v_add_u32 v20, 110592, v20
    v_xor_b32 v21, 64, v20
    v_mov_b32 v26, v20
    v_mov_b32 v27, v21
    v_add_u32 v28, s69, v20
    v_add_u32 v29, s69, v21
    v_lshlrev_b32 v22, 4, v9
    v_add_u32 v22, 158720, v22
    s_lshl_b32 s68, s6, 7
    v_add_u32 v23, s68, v22
    s_lshl_b32 s44, s7, 11
    v_mov_b32 v136, 0
    v_mov_b32 v137, 0
    v_mov_b32 v138, 0
    v_mov_b32 v139, 0
    v_mov_b32 v140, 0
    v_mov_b32 v141, 0
    v_mov_b32 v142, 0
    v_mov_b32 v143, 0
    v_mov_b32 v152, 0
    v_mov_b32 v153, 0
    v_mov_b32 v154, 0
    v_mov_b32 v155, 0
    v_mov_b32 v156, 0
    v_mov_b32 v157, 0
    v_mov_b32 v158, 0
    v_mov_b32 v159, 0
    v_mov_b32 v168, 0
    v_mov_b32 v169, 0
    v_mov_b32 v170, 0
    v_mov_b32 v171, 0
    v_mov_b32 v172, 0
    v_mov_b32 v173, 0
    v_mov_b32 v174, 0
    v_mov_b32 v175, 0
    v_mov_b32 v72, 0
    v_mov_b32 v73, 0
    v_mov_b32 v74, 0
    v_mov_b32 v75, 0
    v_mov_b32 v76, 0
    v_mov_b32 v77, 0
    v_mov_b32 v78, 0
    v_mov_b32 v79, 0
    v_mov_b32 v88, 0
    v_mov_b32 v89, 0
    v_mov_b32 v90, 0
    v_mov_b32 v91, 0
    v_mov_b32 v92, 0
    v_mov_b32 v93, 0
    v_mov_b32 v94, 0
    v_mov_b32 v95, 0
    s_sub_u32 s48, s6, 1
    s_cmp_eq_u32 s6, 0
    s_cselect_b32 s48, 8, s48
    s_lshl_b32 s48, s48, 6
    v_lshlrev_b32 v11, 3, v9
    v_add_u32 v11, s48, v11
    v_cvt_f32_u32 v11, v11
    s_lshl_b32 s49, s3, 5
    s_lshl_b32 s50, s7, 4
    s_add_u32 s50, s50, s49
    s_lshl_b32 s49, s3, 2
    s_add_u32 s49, s49, 256
    v_add_u32 v12, s50, v8
    v_cvt_f32_u32 v12, v12
    v_mul_f32 v10, 0x3de38e39, v12
    v_mul_f32 v12, 0x3ae38e39, v12
    v_mul_f32 v13, v12, v11
    v_cos_f32 v232, v10
    v_sin_f32 v233, v10
    v_fmamk_f32 v30, v12, 0x00000000, v13
    v_fract_f32 v30, v30
    v_fmamk_f32 v31, v12, 0x3f800000, v13
    v_fract_f32 v31, v31
    v_cos_f32 v32, v30
    v_cos_f32 v33, v31
    v_sin_f32 v34, v30
    v_sin_f32 v35, v31
    v_cvt_pk_bf16_f32 v176, v32, v33
    v_cvt_pk_bf16_f32 v184, -v34, -v35
    v_fmamk_f32 v30, v12, 0x40000000, v13
    v_fract_f32 v30, v30
    v_fmamk_f32 v31, v12, 0x40400000, v13
    v_fract_f32 v31, v31
    v_cos_f32 v32, v30
    v_cos_f32 v33, v31
    v_sin_f32 v34, v30
    v_sin_f32 v35, v31
    v_cvt_pk_bf16_f32 v177, v32, v33
    v_cvt_pk_bf16_f32 v185, -v34, -v35
    v_fmamk_f32 v30, v12, 0x40800000, v13
    v_fract_f32 v30, v30
    v_fmamk_f32 v31, v12, 0x40a00000, v13
    v_fract_f32 v31, v31
    v_cos_f32 v32, v30
    v_cos_f32 v33, v31
    v_sin_f32 v34, v30
    v_sin_f32 v35, v31
    v_cvt_pk_bf16_f32 v178, v32, v33
    v_cvt_pk_bf16_f32 v186, -v34, -v35
    v_fmamk_f32 v30, v12, 0x40c00000, v13
    v_fract_f32 v30, v30
    v_fmamk_f32 v31, v12, 0x40e00000, v13
    v_fract_f32 v31, v31
    v_cos_f32 v32, v30
    v_cos_f32 v33, v31
    v_sin_f32 v34, v30
    v_sin_f32 v35, v31
    v_cvt_pk_bf16_f32 v179, v32, v33
    v_cvt_pk_bf16_f32 v187, -v34, -v35
    v_fmamk_f32 v30, v12, 0x42000000, v13
    v_fract_f32 v30, v30
    v_fmamk_f32 v31, v12, 0x42040000, v13
    v_fract_f32 v31, v31
    v_cos_f32 v32, v30
    v_cos_f32 v33, v31
    v_sin_f32 v34, v30
    v_sin_f32 v35, v31
    v_cvt_pk_bf16_f32 v180, v32, v33
    v_cvt_pk_bf16_f32 v188, -v34, -v35
    v_fmamk_f32 v30, v12, 0x42080000, v13
    v_fract_f32 v30, v30
    v_fmamk_f32 v31, v12, 0x420c0000, v13
    v_fract_f32 v31, v31
    v_cos_f32 v32, v30
    v_cos_f32 v33, v31
    v_sin_f32 v34, v30
    v_sin_f32 v35, v31
    v_cvt_pk_bf16_f32 v181, v32, v33
    v_cvt_pk_bf16_f32 v189, -v34, -v35
    v_fmamk_f32 v30, v12, 0x42100000, v13
    v_fract_f32 v30, v30
    v_fmamk_f32 v31, v12, 0x42140000, v13
    v_fract_f32 v31, v31
    v_cos_f32 v32, v30
    v_cos_f32 v33, v31
    v_sin_f32 v34, v30
    v_sin_f32 v35, v31
    v_cvt_pk_bf16_f32 v182, v32, v33
    v_cvt_pk_bf16_f32 v190, -v34, -v35
    v_fmamk_f32 v30, v12, 0x42180000, v13
    v_fract_f32 v30, v30
    v_fmamk_f32 v31, v12, 0x421c0000, v13
    v_fract_f32 v31, v31
    v_cos_f32 v32, v30
    v_cos_f32 v33, v31
    v_sin_f32 v34, v30
    v_sin_f32 v35, v31
    v_cvt_pk_bf16_f32 v183, v32, v33
    v_cvt_pk_bf16_f32 v191, -v34, -v35
    v_and_b32 v12, 7, v8
    v_add_u32 v12, s49, v12
    v_cvt_f32_u32 v12, v12
    v_mul_f32 v10, 0x3de38e39, v12
    v_mul_f32 v12, 0x3ae38e39, v12
    v_mul_f32 v13, v12, v11
    v_cos_f32 v234, v10
    v_sin_f32 v235, v10
    v_cmp_gt_u32 vcc, 8, v8
    v_add_f32 v4, 0x3e800000, v13
    v_sub_f32 v5, 0, v235
    v_cndmask_b32 v13, v4, v13, vcc
    v_cndmask_b32 v235, v235, v5, vcc
    v_cmp_eq_u32 vcc, 5, v8
    v_mov_b32 v4, 1.0
    v_mov_b32 v5, 0
    v_cndmask_b32 v234, v234, v4, vcc
    v_cndmask_b32 v235, v235, v5, vcc
    v_fmamk_f32 v30, v12, 0x00000000, v13
    v_fract_f32 v30, v30
    v_fmamk_f32 v31, v12, 0x3f800000, v13
    v_fract_f32 v31, v31
    v_cos_f32 v32, v30
    v_cos_f32 v33, v31
    s_nop 0
    v_cvt_pk_bf16_f32 v192, v32, v33
    v_fmamk_f32 v30, v12, 0x40000000, v13
    v_fract_f32 v30, v30
    v_fmamk_f32 v31, v12, 0x40400000, v13
    v_fract_f32 v31, v31
    v_cos_f32 v32, v30
    v_cos_f32 v33, v31
    s_nop 0
    v_cvt_pk_bf16_f32 v193, v32, v33
    v_fmamk_f32 v30, v12, 0x40800000, v13
    v_fract_f32 v30, v30
    v_fmamk_f32 v31, v12, 0x40a00000, v13
    v_fract_f32 v31, v31
    v_cos_f32 v32, v30
    v_cos_f32 v33, v31
    s_nop 0
    v_cvt_pk_bf16_f32 v194, v32, v33
    v_fmamk_f32 v30, v12, 0x40c00000, v13
    v_fract_f32 v30, v30
    v_fmamk_f32 v31, v12, 0x40e00000, v13
    v_fract_f32 v31, v31
    v_cos_f32 v32, v30
    v_cos_f32 v33, v31
    s_nop 0
    v_cvt_pk_bf16_f32 v195, v32, v33
    v_fmamk_f32 v30, v12, 0x42000000, v13
    v_fract_f32 v30, v30
    v_fmamk_f32 v31, v12, 0x42040000, v13
    v_fract_f32 v31, v31
    v_cos_f32 v32, v30
    v_cos_f32 v33, v31
    s_nop 0
    v_cvt_pk_bf16_f32 v196, v32, v33
    v_fmamk_f32 v30, v12, 0x42080000, v13
    v_fract_f32 v30, v30
    v_fmamk_f32 v31, v12, 0x420c0000, v13
    v_fract_f32 v31, v31
    v_cos_f32 v32, v30
    v_cos_f32 v33, v31
    s_nop 0
    v_cvt_pk_bf16_f32 v197, v32, v33
    v_fmamk_f32 v30, v12, 0x42100000, v13
    v_fract_f32 v30, v30
    v_fmamk_f32 v31, v12, 0x42140000, v13
    v_fract_f32 v31, v31
    v_cos_f32 v32, v30
    v_cos_f32 v33, v31
    s_nop 0
    v_cvt_pk_bf16_f32 v198, v32, v33
    v_fmamk_f32 v30, v12, 0x42180000, v13
    v_fract_f32 v30, v30
    v_fmamk_f32 v31, v12, 0x421c0000, v13
    v_fract_f32 v31, v31
    v_cos_f32 v32, v30
    v_cos_f32 v33, v31
    s_nop 0
    v_cvt_pk_bf16_f32 v199, v32, v33
    v_lshlrev_b32 v11, 2, v9
    v_cvt_f32_u32 v11, v11
    v_add_u32 v12, 0, v8
    v_cvt_f32_u32 v12, v12
    v_mul_f32 v12, 0x3d000000, v12
    v_mul_f32 v13, v12, v11
    v_fmamk_f32 v30, v12, 0x00000000, v13
    v_fmamk_f32 v31, v12, 0x3f800000, v13
    v_cos_f32 v32, v30
    v_cos_f32 v33, v31
    v_sin_f32 v34, v30
    v_sin_f32 v35, v31
    v_cvt_pk_bf16_f32 v112, v32, v33
    v_cvt_pk_bf16_f32 v120, v34, v35
    v_xor_b32 v128, 0x80008000, v120
    v_fmamk_f32 v30, v12, 0x40000000, v13
    v_fmamk_f32 v31, v12, 0x40400000, v13
    v_cos_f32 v32, v30
    v_cos_f32 v33, v31
    v_sin_f32 v34, v30
    v_sin_f32 v35, v31
    v_cvt_pk_bf16_f32 v113, v32, v33
    v_cvt_pk_bf16_f32 v121, v34, v35
    v_xor_b32 v129, 0x80008000, v121
    v_fmamk_f32 v30, v12, 0x41800000, v13
    v_fmamk_f32 v31, v12, 0x41880000, v13
    v_cos_f32 v32, v30
    v_cos_f32 v33, v31
    v_sin_f32 v34, v30
    v_sin_f32 v35, v31
    v_cvt_pk_bf16_f32 v114, v32, v33
    v_cvt_pk_bf16_f32 v122, v34, v35
    v_xor_b32 v130, 0x80008000, v122
    v_fmamk_f32 v30, v12, 0x41900000, v13
    v_fmamk_f32 v31, v12, 0x41980000, v13
    v_cos_f32 v32, v30
    v_cos_f32 v33, v31
    v_sin_f32 v34, v30
    v_sin_f32 v35, v31
    v_cvt_pk_bf16_f32 v115, v32, v33
    v_cvt_pk_bf16_f32 v123, v34, v35
    v_xor_b32 v131, 0x80008000, v123
    v_add_u32 v12, 16, v8
    v_cvt_f32_u32 v12, v12
    v_mul_f32 v12, 0x3d000000, v12
    v_mul_f32 v13, v12, v11
    v_fmamk_f32 v30, v12, 0x00000000, v13
    v_fmamk_f32 v31, v12, 0x3f800000, v13
    v_cos_f32 v32, v30
    v_cos_f32 v33, v31
    v_sin_f32 v34, v30
    v_sin_f32 v35, v31
    v_cvt_pk_bf16_f32 v116, v32, v33
    v_cvt_pk_bf16_f32 v124, v34, v35
    v_xor_b32 v132, 0x80008000, v124
    v_fmamk_f32 v30, v12, 0x40000000, v13
    v_fmamk_f32 v31, v12, 0x40400000, v13
    v_cos_f32 v32, v30
    v_cos_f32 v33, v31
    v_sin_f32 v34, v30
    v_sin_f32 v35, v31
    v_cvt_pk_bf16_f32 v117, v32, v33
    v_cvt_pk_bf16_f32 v125, v34, v35
    v_xor_b32 v133, 0x80008000, v125
    v_fmamk_f32 v30, v12, 0x41800000, v13
    v_fmamk_f32 v31, v12, 0x41880000, v13
    v_cos_f32 v32, v30
    v_cos_f32 v33, v31
    v_sin_f32 v34, v30
    v_sin_f32 v35, v31
    v_cvt_pk_bf16_f32 v118, v32, v33
    v_cvt_pk_bf16_f32 v126, v34, v35
    v_xor_b32 v134, 0x80008000, v126
    v_fmamk_f32 v30, v12, 0x41900000, v13
    v_fmamk_f32 v31, v12, 0x41980000, v13
    v_cos_f32 v32, v30
    v_cos_f32 v33, v31
    v_sin_f32 v34, v30
    v_sin_f32 v35, v31
    v_cvt_pk_bf16_f32 v119, v32, v33
    v_cvt_pk_bf16_f32 v127, v34, v35
    v_xor_b32 v135, 0x80008000, v127
    s_mov_b32 s46, 0
    s_mov_b32 s47, 0
    s_and_b32 s45, s4, 2
    s_mov_b32 s53, 1
    s_mov_b32 s51, 0
    s_waitcnt vmcnt(0)
    s_cmp_eq_u32 s14, 0
    s_cbranch_scc0 AX_L
    v_mov_b32 v255, 1
    s_lshl_b32 s48, s3, 2
    s_mov_b64 exec, 1
    buffer_store_dword v255, v231, s[40:43], s48 offen sc1
    s_mov_b64 exec, -1
AX_L:
    s_barrier
    ds_read_b128 v[36:39], v26 offset:0
    ds_read_b128 v[40:43], v26 offset:2048
    ds_read_b128 v[44:47], v26 offset:4096
    ds_read_b128 v[48:51], v26 offset:6144
    ds_read_b128 v[52:55], v28 offset:0
    ds_read_b128 v[56:59], v28 offset:2048
    s_mov_b32 exec_lo, 0x00200020
    s_mov_b32 exec_hi, 0x00200020
    ds_read_b128 v[192:195], v23 offset:0
    s_mov_b64 exec, -1
    s_sub_u32 s51, s51, 1
    s_cbranch_scc1 AX_B0
AX_S0:
    v_mul_f32 v144, v232, v72
    v_mul_f32 v160, v232, v88
    v_fma_f32 v144, -v233, v88, v144
    v_fmac_f32 v160, v233, v72
    v_mul_f32 v145, v232, v73
    v_mul_f32 v161, v232, v89
    v_fma_f32 v145, -v233, v89, v145
    v_fmac_f32 v161, v233, v73
    s_waitcnt lgkmcnt(0)
    v_mfma_f32_16x16x32_bf16 v[64:67], v[36:39], v[176:179], v[136:139]
    v_mul_f32 v146, v232, v74
    v_mul_f32 v162, v232, v90
    v_fma_f32 v146, -v233, v90, v146
    v_fmac_f32 v162, v233, v74
    v_mfma_f32_16x16x32_bf16 v[80:83], v[36:39], v[184:187], v[152:155]
    v_mul_f32 v147, v232, v75
    v_mul_f32 v163, v232, v91
    v_fma_f32 v147, -v233, v91, v147
    v_fmac_f32 v163, v233, v75
    v_mfma_f32_16x16x32_bf16 v[68:71], v[40:43], v[176:179], v[140:143]
    v_mul_f32 v148, v232, v76
    v_mul_f32 v164, v232, v92
    v_fma_f32 v148, -v233, v92, v148
    v_fmac_f32 v164, v233, v76
    v_mfma_f32_16x16x32_bf16 v[84:87], v[40:43], v[184:187], v[156:159]
    v_mul_f32 v149, v232, v77
    v_mul_f32 v165, v232, v93
    v_fma_f32 v149, -v233, v93, v149
    v_fmac_f32 v165, v233, v77
    v_mfma_f32_16x16x32_bf16 v[96:99], v[52:55], v[192:195], v[168:171]
    v_mul_f32 v150, v232, v78
    v_mul_f32 v166, v232, v94
    v_fma_f32 v150, -v233, v94, v150
    v_fmac_f32 v166, v233, v78
    v_mfma_f32_16x16x32_bf16 v[100:103], v[56:59], v[192:195], v[172:175]
    v_mul_f32 v151, v232, v79
    v_mul_f32 v167, v232, v95
    v_fma_f32 v151, -v233, v95, v151
    v_fmac_f32 v167, v233, v79
    v_mfma_f32_16x16x32_bf16 v[72:75], v[44:47], v[176:179], v[144:147]
    v_mfma_f32_16x16x32_bf16 v[88:91], v[44:47], v[184:187], v[160:163]
    v_mfma_f32_16x16x32_bf16 v[76:79], v[48:51], v[176:179], v[148:151]
    v_mfma_f32_16x16x32_bf16 v[92:95], v[48:51], v[184:187], v[164:167]
    s_barrier
    ds_read_b128 v[36:39], v27 offset:0
    ds_read_b128 v[40:43], v27 offset:2048
    ds_read_b128 v[44:47], v27 offset:4096
    ds_read_b128 v[48:51], v27 offset:6144
    ds_read_b128 v[52:55], v29 offset:0
    ds_read_b128 v[56:59], v29 offset:2048
    s_mov_b32 exec_lo, 0x00200020
    s_mov_b32 exec_hi, 0x00200020
    ds_read_b128 v[196:199], v23 offset:64
    s_mov_b64 exec, -1
    s_sub_u32 s51, s51, 1
    s_cbranch_scc1 AX_B1
AX_S1:
    s_add_u32 s47, s47, 8192
    s_and_b32 s47, s47, 32767
    s_add_u32 s66, s47, s69
    s_add_u32 s68, s68, 128
    s_cmp_eq_u32 s68, 1152
    s_cselect_b32 s68, 0, s68
    v_add_u32 v26, s47, v20
    v_add_u32 v27, s47, v21
    v_add_u32 v28, s66, v20
    v_add_u32 v29, s66, v21
    v_add_u32 v23, s68, v22
    s_waitcnt lgkmcnt(0)
    v_mfma_f32_16x16x32_bf16 v[64:67], v[36:39], v[180:183], v[64:67]
    v_mfma_f32_16x16x32_bf16 v[80:83], v[36:39], v[188:191], v[80:83]
    v_mfma_f32_16x16x32_bf16 v[68:71], v[40:43], v[180:183], v[68:71]
    v_mfma_f32_16x16x32_bf16 v[84:87], v[40:43], v[188:191], v[84:87]
    v_mfma_f32_16x16x32_bf16 v[96:99], v[52:55], v[196:199], v[96:99]
    v_mfma_f32_16x16x32_bf16 v[100:103], v[56:59], v[196:199], v[100:103]
    s_nop 3
    v_mul_f32 v136, v232, v64
    v_mul_f32 v152, v232, v80
    v_fma_f32 v136, -v233, v80, v136
    v_fmac_f32 v152, v233, v64
    v_mfma_f32_16x16x32_bf16 v[72:75], v[44:47], v[180:183], v[72:75]
    v_mul_f32 v137, v232, v65
    v_mul_f32 v153, v232, v81
    v_fma_f32 v137, -v233, v81, v137
    v_fmac_f32 v153, v233, v65
    v_mfma_f32_16x16x32_bf16 v[88:91], v[44:47], v[188:191], v[88:91]
    v_mul_f32 v138, v232, v66
    v_mul_f32 v154, v232, v82
    v_fma_f32 v138, -v233, v82, v138
    v_fmac_f32 v154, v233, v66
    v_mfma_f32_16x16x32_bf16 v[76:79], v[48:51], v[180:183], v[76:79]
    v_mul_f32 v139, v232, v67
    v_mul_f32 v155, v232, v83
    v_fma_f32 v139, -v233, v83, v139
    v_fmac_f32 v155, v233, v67
    v_mfma_f32_16x16x32_bf16 v[92:95], v[48:51], v[188:191], v[92:95]
    s_cmp_eq_u32 s46, 8
    s_cbranch_scc1 AX_D
    v_mul_f32 v140, v232, v68
    v_mul_f32 v156, v232, v84
    v_fma_f32 v140, -v233, v84, v140
    v_fmac_f32 v156, v233, v68
    v_mul_f32 v141, v232, v69
    v_mul_f32 v157, v232, v85
    v_fma_f32 v141, -v233, v85, v141
    v_fmac_f32 v157, v233, v69
    v_mul_f32 v142, v232, v70
    v_mul_f32 v158, v232, v86
    v_fma_f32 v142, -v233, v86, v142
    v_fmac_f32 v158, v233, v70
    v_mul_f32 v143, v232, v71
    v_mul_f32 v159, v232, v87
    v_fma_f32 v143, -v233, v87, v143
    v_fmac_f32 v159, v233, v71
    v_mul_f32 v168, v234, v96
    v_mul_f32 v169, v234, v97
    v_mul_f32 v170, v234, v98
    v_mul_f32 v171, v234, v99
    v_mul_f32 v172, v234, v100
    v_mul_f32 v173, v234, v101
    v_mul_f32 v174, v234, v102
    v_mul_f32 v175, v234, v103
    v_fmac_f32_dpp v168, v96, v235 row_ror:8 row_mask:0xf bank_mask:0xf
    v_fmac_f32_dpp v169, v97, v235 row_ror:8 row_mask:0xf bank_mask:0xf
    v_fmac_f32_dpp v170, v98, v235 row_ror:8 row_mask:0xf bank_mask:0xf
    v_fmac_f32_dpp v171, v99, v235 row_ror:8 row_mask:0xf bank_mask:0xf
    v_fmac_f32_dpp v172, v100, v235 row_ror:8 row_mask:0xf bank_mask:0xf
    v_fmac_f32_dpp v173, v101, v235 row_ror:8 row_mask:0xf bank_mask:0xf
    v_fmac_f32_dpp v174, v102, v235 row_ror:8 row_mask:0xf bank_mask:0xf
    v_fmac_f32_dpp v175, v103, v235 row_ror:8 row_mask:0xf bank_mask:0xf
    s_lshr_b32 s66, s45, 1
    s_xor_b32 s66, s66, s46
    s_add_u32 s46, s46, 1
    s_bitcmp1_b32 s66, 0
    s_cbranch_scc1 AX_W0
    s_cmp_eq_u32 s46, 1
    s_cbranch_scc0 AX_L
    s_waitcnt vmcnt(8)
    s_branch AX_L
AX_W0:
    s_waitcnt vmcnt(0)
    s_branch AX_L
AX_B0:
    s_cmp_ge_u32 s46, 5
    s_cselect_b32 s51, 100, 3
    s_add_u32 s52, s46, 3
    s_min_u32 s52, s52, 8
    s_cmp_eq_u32 s46, 0
    s_cbranch_scc0 AX_C0
    s_lshr_b32 s52, s45, 1
    s_add_u32 s52, s52, 1
    s_sub_u32 s51, s45, 1
    s_cmp_ge_u32 s45, 2
    s_cselect_b32 s51, s51, 0
AX_C0:
    s_lshl_b32 s67, s64, 7
    s_add_u32 s67, s67, s18
    s_mov_b32 m0, s65
    s_nop 0
    buffer_load_dwordx4 v16, s[8:11], s67 offen offset:0 lds
    buffer_load_dwordx4 v17, s[8:11], s67 offen offset:1024 lds
    s_mov_b32 m0, s65
    s_nop 0
    buffer_load_dwordx4 v18, s[8:11], s67 offen offset:2048 lds
    buffer_load_dwordx4 v19, s[8:11], s67 offen offset:3072 lds
    s_add_u32 s64, s64, 1
    s_cmp_eq_u32 s64, 9
    s_cselect_b32 s64, 0, s64
    s_add_u32 s65, s65, 8192
    s_sub_u32 s66, s65, 32768
    s_cmp_ge_u32 s65, 143360
    s_cselect_b32 s65, s66, s65
    s_add_u32 s53, s53, 1
    s_cmp_le_u32 s53, s52
    s_cbranch_scc1 AX_C0
    s_cmp_eq_u32 s46, 0
    s_cbranch_scc1 AX_S0
    v_add_u32 v4, s3, v62
    v_and_b32 v4, 7, v4
    v_cmp_eq_u32 vcc, 0, v62
    v_mov_b32 v5, 8
    v_add_u32 v62, 3, v62
    v_cndmask_b32 v4, v4, v5, vcc
    v_lshl_add_u32 v4, v4, 7, v24
    s_mov_b32 exec_lo, 0x7ffffff
    s_mov_b32 exec_hi, 0
    buffer_load_dword v15, v4, s[24:27], s19 offen
    s_mov_b64 exec, -1
    s_cmp_ge_u32 s46, 5
    s_cbranch_scc0 AX_S0
    buffer_load_dword v254, v63, s[40:43], 0 offen sc1
    s_branch AX_S0
AX_B1:
    s_cmp_ge_u32 s46, 5
    s_cselect_b32 s51, 100, 3
    s_add_u32 s52, s46, 3
    s_min_u32 s52, s52, 8
    s_cmp_eq_u32 s46, 0
    s_cbranch_scc0 AX_C1
    s_add_u32 s51, s45, 2
AX_C1:
    s_lshl_b32 s67, s64, 7
    s_add_u32 s67, s67, s18
    s_mov_b32 m0, s65
    s_nop 0
    buffer_load_dwordx4 v16, s[8:11], s67 offen offset:0 lds
    buffer_load_dwordx4 v17, s[8:11], s67 offen offset:1024 lds
    s_mov_b32 m0, s65
    s_nop 0
    buffer_load_dwordx4 v18, s[8:11], s67 offen offset:2048 lds
    buffer_load_dwordx4 v19, s[8:11], s67 offen offset:3072 lds
    s_add_u32 s64, s64, 1
    s_cmp_eq_u32 s64, 9
    s_cselect_b32 s64, 0, s64
    s_add_u32 s65, s65, 8192
    s_sub_u32 s66, s65, 32768
    s_cmp_ge_u32 s65, 143360
    s_cselect_b32 s65, s66, s65
    s_add_u32 s53, s53, 1
    s_cmp_le_u32 s53, s52
    s_cbranch_scc1 AX_C1
    s_cmp_eq_u32 s46, 0
    s_cbranch_scc1 AX_S1
    v_add_u32 v4, s3, v62
    v_and_b32 v4, 7, v4
    v_cmp_eq_u32 vcc, 0, v62
    v_mov_b32 v5, 8
    v_add_u32 v62, 3, v62
    v_cndmask_b32 v4, v4, v5, vcc
    v_lshl_add_u32 v4, v4, 7, v24
    s_mov_b32 exec_lo, 0x7ffffff
    s_mov_b32 exec_hi, 0
    buffer_load_dword v15, v4, s[24:27], s19 offen
    s_mov_b64 exec, -1
    s_cmp_ge_u32 s46, 5
    s_cbranch_scc0 AX_S1
    buffer_load_dword v254, v63, s[40:43], 0 offen sc1
    s_branch AX_S1
K_MAIN:
    v_lshlrev_b32 v7, 2, v0
    s_lshl_b32 s16, s5, 8
    s_add_u32 s16, s16, 155648
    v_add_u32 v3, s16, v7
    v_mov_b32 v8, 0
    ds_write_b32 v3, v8 offset:0
    ds_write_b32 v3, v8 offset:1024
    ds_write_b32 v3, v8 offset:2048
    v_add_u32 v13, 1024, v3
    v_and_b32 v3, 1, v0
    v_mul_u32_u24 v3, 260, v3
    v_add_u32 v14, 155648, v3
    v_mov_b32 v5, 0
    v_and_b32 v200, 15, v0
    v_lshrrev_b32 v201, 4, v0
    s_movk_i32 s17, 1152
    v_lshrrev_b32 v202, 2, v200
    v_and_b32 v203, 3, v0
    v_lshl_add_u32 v204, v201, 3, v202
    v_mul_u32_u24 v204, s17, v204
    v_lshl_add_u32 v204, v203, 3, v204
    v_lshrrev_b32 v205, 1, v202
    v_and_b32 v7, 1, v201
    v_lshl_add_u32 v205, v7, 1, v205
    s_mul_i32 s18, s5, 10
    s_cmp_eq_u32 s5, 3
    s_cselect_b32 s18, 28, s18
    s_add_u32 s16, s18, 0
    s_and_b32 s17, s16, 3
    s_lshr_b32 s16, s16, 2
    s_lshl_b32 s16, s16, 7
    v_xor_b32 v7, s17, v205
    v_lshl_add_u32 v7, v7, 5, v204
    v_add_u32 v88, s16, v7
    v_mov_b32 v92, v88
    s_add_u32 s16, s18, 1
    s_and_b32 s17, s16, 3
    s_lshr_b32 s16, s16, 2
    s_lshl_b32 s16, s16, 7
    v_xor_b32 v7, s17, v205
    v_lshl_add_u32 v7, v7, 5, v204
    v_add_u32 v89, s16, v7
    v_mov_b32 v93, v89
    s_add_u32 s16, s18, 2
    s_and_b32 s17, s16, 3
    s_lshr_b32 s16, s16, 2
    s_lshl_b32 s16, s16, 7
    v_xor_b32 v7, s17, v205
    v_lshl_add_u32 v7, v7, 5, v204
    v_add_u32 v90, s16, v7
    v_mov_b32 v94, v90
    s_add_u32 s16, s18, 3
    s_and_b32 s17, s16, 3
    s_lshr_b32 s16, s16, 2
    s_lshl_b32 s16, s16, 7
    v_xor_b32 v7, s17, v205
    v_lshl_add_u32 v7, v7, 5, v204
    v_add_u32 v91, s16, v7
    v_mov_b32 v95, v91
    v_lshrrev_b32 v7, 1, v200
    v_xor_b32 v7, v7, v201
    v_lshlrev_b32 v7, 4, v7
    v_lshl_add_u32 v1, v200, 7, v7
    v_add_u32 v1, 110592, v1
    s_lshl_b32 s16, s98, 6
    v_xor_b32 v1, s16, v1
    v_xor_b32 v2, 64, v1
    v_mov_b32 v3, v1
    v_mov_b32 v4, v2
    v_lshlrev_b32 v12, 4, v0
    s_lshr_b32 s16, s5, 1
    s_lshl_b32 s16, s16, 11
    s_add_u32 s16, s16, 73728
    v_add_u32 v9, s16, v12
    v_lshl_add_u32 v204, v201, 2, v202
    v_bfe_u32 v205, v204, 1, 2
    v_lshlrev_b32 v204, 7, v204
    v_lshl_add_u32 v204, v203, 3, v204
    s_and_b32 s16, s5, 1
    s_lshl_b32 s16, s16, 1
    s_add_u32 s17, s16, 0
    v_xor_b32 v7, s17, v205
    v_lshl_add_u32 v10, v7, 5, v204
    s_add_u32 s17, s16, 1
    v_xor_b32 v7, s17, v205
    v_lshl_add_u32 v11, v7, 5, v204
    v_mov_b64 v[96:97], 0
    v_mov_b64 v[98:99], 0
    v_mov_b64 v[100:101], 0
    v_mov_b64 v[102:103], 0
    v_mov_b64 v[104:105], 0
    v_mov_b64 v[106:107], 0
    v_mov_b64 v[108:109], 0
    v_mov_b64 v[110:111], 0
    v_mov_b64 v[112:113], 0
    v_mov_b64 v[114:115], 0
    v_mov_b64 v[116:117], 0
    v_mov_b64 v[118:119], 0
    v_mov_b64 v[120:121], 0
    v_mov_b64 v[122:123], 0
    v_mov_b64 v[124:125], 0
    v_mov_b64 v[126:127], 0
    v_mov_b64 v[128:129], 0
    v_mov_b64 v[130:131], 0
    v_mov_b64 v[132:133], 0
    v_mov_b64 v[134:135], 0
    v_mov_b64 v[136:137], 0
    v_mov_b64 v[138:139], 0
    v_mov_b64 v[140:141], 0
    v_mov_b64 v[142:143], 0
    v_mov_b64 v[144:145], 0
    v_mov_b64 v[146:147], 0
    v_mov_b64 v[148:149], 0
    v_mov_b64 v[150:151], 0
    v_mov_b64 v[152:153], 0
    v_mov_b64 v[154:155], 0
    v_mov_b64 v[156:157], 0
    v_mov_b64 v[158:159], 0
    v_mov_b64 v[160:161], 0
    v_mov_b64 v[162:163], 0
    v_mov_b64 v[164:165], 0
    v_mov_b64 v[166:167], 0
    v_mov_b64 v[168:169], 0
    v_mov_b64 v[170:171], 0
    v_mov_b64 v[172:173], 0
    v_mov_b64 v[174:175], 0
    v_mov_b64 v[176:177], 0
    v_mov_b64 v[178:179], 0
    v_mov_b64 v[180:181], 0
    v_mov_b64 v[182:183], 0
    v_mov_b64 v[184:185], 0
    v_mov_b64 v[186:187], 0
    v_mov_b64 v[188:189], 0
    v_mov_b64 v[190:191], 0
    v_mov_b64 v[192:193], 0
    v_mov_b64 v[194:195], 0
    v_mov_b64 v[196:197], 0
    v_mov_b64 v[198:199], 0
    v_mov_b64 v[200:201], 0
    v_mov_b64 v[202:203], 0
    v_mov_b64 v[204:205], 0
    v_mov_b64 v[206:207], 0
    v_mov_b64 v[208:209], 0
    v_mov_b64 v[210:211], 0
    v_mov_b64 v[212:213], 0
    v_mov_b64 v[214:215], 0
    v_mov_b64 v[216:217], 0
    v_mov_b64 v[218:219], 0
    v_mov_b64 v[220:221], 0
    v_mov_b64 v[222:223], 0
    v_mov_b64 v[36:37], 0
    v_mov_b64 v[38:39], 0
    v_mov_b64 v[40:41], 0
    v_mov_b64 v[42:43], 0
    v_mov_b64 v[44:45], 0
    v_mov_b64 v[46:47], 0
    v_mov_b64 v[48:49], 0
    v_mov_b64 v[50:51], 0
    v_mov_b64 v[52:53], 0
    v_mov_b64 v[54:55], 0
    v_mov_b64 v[72:73], 0
    v_mov_b64 v[74:75], 0
    v_mov_b64 v[76:77], 0
    v_mov_b64 v[78:79], 0
    v_mov_b64 v[80:81], 0
    v_mov_b64 v[82:83], 0
    v_mov_b64 v[84:85], 0
    v_mov_b64 v[86:87], 0
    s_waitcnt lgkmcnt(0)
    s_mov_b32 s32, s62
    s_mov_b32 s33, s63
    s_mov_b32 s34, 28311552
    s_mov_b32 s35, 0x20000
    s_lshl_b32 s16, s18, 11
    s_add_u32 s16, s16, 73728
    v_add_u32 v8, s16, v12
    s_mov_b32 s64, 0
    s_mov_b32 s65, 0
    s_mov_b32 s66, 1
    s_cmp_ge_u32 s5, 2
    s_cbranch_scc1 MBL
    v_mov_b64 v[224:225], 0
    v_mov_b64 v[226:227], 0
    v_mov_b64 v[228:229], 0
    v_mov_b64 v[230:231], 0
    v_mov_b64 v[232:233], 0
    v_mov_b64 v[234:235], 0
    v_mov_b64 v[236:237], 0
    v_mov_b64 v[238:239], 0
    v_mov_b64 v[240:241], 0
    v_mov_b64 v[242:243], 0
    v_mov_b64 v[244:245], 0
    v_mov_b64 v[246:247], 0
    v_mov_b64 v[248:249], 0
    v_mov_b64 v[250:251], 0
    v_mov_b64 v[252:253], 0
    v_mov_b64 v[254:255], 0
MAL:
    s_barrier
    ds_read_b64_tr_b16 v[16:17], v92 offset:0
    v_mfma_f32_16x16x32_bf16 v[208:211], v[44:47], v[72:75], v[208:211]
    ds_read_b64_tr_b16 v[18:19], v92 offset:4608
    v_mfma_f32_16x16x32_bf16 v[212:215], v[44:47], v[76:79], v[212:215]
    ds_read_b128 v[56:59], v3 offset:0
    v_mfma_f32_16x16x32_bf16 v[216:219], v[44:47], v[80:83], v[216:219]
    ds_read_b128 v[60:63], v3 offset:2048
    v_mfma_f32_16x16x32_bf16 v[220:223], v[44:47], v[84:87], v[220:223]
    ds_read_b128 v[64:67], v3 offset:4096
    v_mfma_f32_16x16x32_bf16 v[224:227], v[48:51], v[72:75], v[224:227]
    ds_read_b128 v[68:71], v3 offset:6144
    v_mfma_f32_16x16x32_bf16 v[228:231], v[48:51], v[76:79], v[228:231]
    ds_read_b64_tr_b16 v[20:21], v93 offset:0
    v_mfma_f32_16x16x32_bf16 v[232:235], v[48:51], v[80:83], v[232:235]
    ds_read_b64_tr_b16 v[22:23], v93 offset:4608
    v_mfma_f32_16x16x32_bf16 v[236:239], v[48:51], v[84:87], v[236:239]
    ds_read_b64_tr_b16 v[24:25], v94 offset:0
    v_mfma_f32_16x16x32_bf16 v[240:243], v[52:55], v[72:75], v[240:243]
    ds_read_b64_tr_b16 v[26:27], v94 offset:4608
    v_mfma_f32_16x16x32_bf16 v[244:247], v[52:55], v[76:79], v[244:247]
    ds_read_b64_tr_b16 v[28:29], v95 offset:0
    v_mfma_f32_16x16x32_bf16 v[248:251], v[52:55], v[80:83], v[248:251]
    ds_read_b64_tr_b16 v[30:31], v95 offset:4608
    v_mfma_f32_16x16x32_bf16 v[252:255], v[52:55], v[84:87], v[252:255]
    ds_read_b64_tr_b16 v[32:33], v92 offset:128
    s_waitcnt lgkmcnt(10)
    v_mfma_f32_16x16x32_bf16 v[96:99], v[16:19], v[56:59], v[96:99]
    ds_read_b64_tr_b16 v[34:35], v92 offset:4736
    s_waitcnt lgkmcnt(10)
    v_mfma_f32_16x16x32_bf16 v[100:103], v[16:19], v[60:63], v[100:103]
    ds_read_b64_tr_b16 v[36:37], v93 offset:128
    s_waitcnt lgkmcnt(10)
    v_mfma_f32_16x16x32_bf16 v[104:107], v[16:19], v[64:67], v[104:107]
    ds_read_b64_tr_b16 v[38:39], v93 offset:4736
    s_waitcnt lgkmcnt(10)
    v_mfma_f32_16x16x32_bf16 v[108:111], v[16:19], v[68:71], v[108:111]
    ds_read_b64_tr_b16 v[40:41], v94 offset:128
    s_waitcnt lgkmcnt(9)
    v_mfma_f32_16x16x32_bf16 v[112:115], v[20:23], v[56:59], v[112:115]
    ds_read_b64_tr_b16 v[42:43], v94 offset:4736
    v_mfma_f32_16x16x32_bf16 v[116:119], v[20:23], v[60:63], v[116:119]
    ds_read_b64_tr_b16 v[44:45], v95 offset:128
    v_mfma_f32_16x16x32_bf16 v[120:123], v[20:23], v[64:67], v[120:123]
    ds_read_b64_tr_b16 v[46:47], v95 offset:4736
    v_mfma_f32_16x16x32_bf16 v[124:127], v[20:23], v[68:71], v[124:127]
    ds_read_b64_tr_b16 v[48:49], v92 offset:256
    s_waitcnt lgkmcnt(11)
    v_mfma_f32_16x16x32_bf16 v[128:131], v[24:27], v[56:59], v[128:131]
    ds_read_b64_tr_b16 v[50:51], v92 offset:4864
    v_mfma_f32_16x16x32_bf16 v[132:135], v[24:27], v[60:63], v[132:135]
    ds_read_b64_tr_b16 v[52:53], v93 offset:256
    v_mfma_f32_16x16x32_bf16 v[136:139], v[24:27], v[64:67], v[136:139]
    ds_read_b64_tr_b16 v[54:55], v93 offset:4864
    v_mfma_f32_16x16x32_bf16 v[140:143], v[24:27], v[68:71], v[140:143]
    s_add_u32 s64, s64, 36864
    s_waitcnt lgkmcnt(12)
    v_mfma_f32_16x16x32_bf16 v[144:147], v[28:31], v[56:59], v[144:147]
    s_cmp_eq_u32 s64, 110592
    v_mfma_f32_16x16x32_bf16 v[148:151], v[28:31], v[60:63], v[148:151]
    s_cselect_b32 s64, 0, s64
    v_mfma_f32_16x16x32_bf16 v[152:155], v[28:31], v[64:67], v[152:155]
    s_add_u32 s66, s66, 1
    v_mfma_f32_16x16x32_bf16 v[156:159], v[28:31], v[68:71], v[156:159]
    v_add_u32 v92, s64, v88
    s_waitcnt lgkmcnt(10)
    v_mfma_f32_16x16x32_bf16 v[160:163], v[32:35], v[56:59], v[160:163]
    v_add_u32 v93, s64, v89
    v_mfma_f32_16x16x32_bf16 v[164:167], v[32:35], v[60:63], v[164:167]
    v_add_u32 v94, s64, v90
    v_mfma_f32_16x16x32_bf16 v[168:171], v[32:35], v[64:67], v[168:171]
    v_add_u32 v95, s64, v91
    v_mfma_f32_16x16x32_bf16 v[172:175], v[32:35], v[68:71], v[172:175]
    s_cmp_eq_u32 s66, 18
    s_waitcnt lgkmcnt(8)
    v_mfma_f32_16x16x32_bf16 v[176:179], v[36:39], v[56:59], v[176:179]
    v_mfma_f32_16x16x32_bf16 v[180:183], v[36:39], v[60:63], v[180:183]
    v_mfma_f32_16x16x32_bf16 v[184:187], v[36:39], v[64:67], v[184:187]
    v_mfma_f32_16x16x32_bf16 v[188:191], v[36:39], v[68:71], v[188:191]
    s_waitcnt lgkmcnt(6)
    v_mfma_f32_16x16x32_bf16 v[192:195], v[40:43], v[56:59], v[192:195]
    v_mfma_f32_16x16x32_bf16 v[196:199], v[40:43], v[60:63], v[196:199]
    v_mfma_f32_16x16x32_bf16 v[200:203], v[40:43], v[64:67], v[200:203]
    v_mfma_f32_16x16x32_bf16 v[204:207], v[40:43], v[68:71], v[204:207]
    s_waitcnt lgkmcnt(0)
    s_cbranch_scc1 MAX
    s_barrier
    ds_read_b64_tr_b16 v[16:17], v92 offset:0
    v_mfma_f32_16x16x32_bf16 v[208:211], v[44:47], v[56:59], v[208:211]
    ds_read_b64_tr_b16 v[18:19], v92 offset:4608
    v_mfma_f32_16x16x32_bf16 v[212:215], v[44:47], v[60:63], v[212:215]
    ds_read_b128 v[72:75], v4 offset:0
    v_mfma_f32_16x16x32_bf16 v[216:219], v[44:47], v[64:67], v[216:219]
    ds_read_b128 v[76:79], v4 offset:2048
    v_mfma_f32_16x16x32_bf16 v[220:223], v[44:47], v[68:71], v[220:223]
    ds_read_b128 v[80:83], v4 offset:4096
    v_mfma_f32_16x16x32_bf16 v[224:227], v[48:51], v[56:59], v[224:227]
    ds_read_b128 v[84:87], v4 offset:6144
    v_mfma_f32_16x16x32_bf16 v[228:231], v[48:51], v[60:63], v[228:231]
    ds_read_b64_tr_b16 v[20:21], v93 offset:0
    v_mfma_f32_16x16x32_bf16 v[232:235], v[48:51], v[64:67], v[232:235]
    ds_read_b64_tr_b16 v[22:23], v93 offset:4608
    v_mfma_f32_16x16x32_bf16 v[236:239], v[48:51], v[68:71], v[236:239]
    ds_read_b64_tr_b16 v[24:25], v94 offset:0
    v_mfma_f32_16x16x32_bf16 v[240:243], v[52:55], v[56:59], v[240:243]
    ds_read_b64_tr_b16 v[26:27], v94 offset:4608
    v_mfma_f32_16x16x32_bf16 v[244:247], v[52:55], v[60:63], v[244:247]
    ds_read_b64_tr_b16 v[28:29], v95 offset:0
    v_mfma_f32_16x16x32_bf16 v[248:251], v[52:55], v[64:67], v[248:251]
    ds_read_b64_tr_b16 v[30:31], v95 offset:4608
    v_mfma_f32_16x16x32_bf16 v[252:255], v[52:55], v[68:71], v[252:255]
    ds_read_b64_tr_b16 v[32:33], v92 offset:128
    s_waitcnt lgkmcnt(10)
    v_mfma_f32_16x16x32_bf16 v[96:99], v[16:19], v[72:75], v[96:99]
    ds_read_b64_tr_b16 v[34:35], v92 offset:4736
    s_waitcnt lgkmcnt(10)
    v_mfma_f32_16x16x32_bf16 v[100:103], v[16:19], v[76:79], v[100:103]
    ds_read_b64_tr_b16 v[36:37], v93 offset:128
    s_waitcnt lgkmcnt(10)
    v_mfma_f32_16x16x32_bf16 v[104:107], v[16:19], v[80:83], v[104:107]
    ds_read_b64_tr_b16 v[38:39], v93 offset:4736
    s_waitcnt lgkmcnt(10)
    v_mfma_f32_16x16x32_bf16 v[108:111], v[16:19], v[84:87], v[108:111]
    ds_read_b64_tr_b16 v[40:41], v94 offset:128
    s_waitcnt lgkmcnt(9)
    v_mfma_f32_16x16x32_bf16 v[112:115], v[20:23], v[72:75], v[112:115]
    ds_read_b64_tr_b16 v[42:43], v94 offset:4736
    v_mfma_f32_16x16x32_bf16 v[116:119], v[20:23], v[76:79], v[116:119]
    ds_read_b64_tr_b16 v[44:45], v95 offset:128
    v_mfma_f32_16x16x32_bf16 v[120:123], v[20:23], v[80:83], v[120:123]
    ds_read_b64_tr_b16 v[46:47], v95 offset:4736
    v_mfma_f32_16x16x32_bf16 v[124:127], v[20:23], v[84:87], v[124:127]
    ds_read_b64_tr_b16 v[48:49], v92 offset:256
    s_waitcnt lgkmcnt(11)
    v_mfma_f32_16x16x32_bf16 v[128:131], v[24:27], v[72:75], v[128:131]
    ds_read_b64_tr_b16 v[50:51], v92 offset:4864
    v_mfma_f32_16x16x32_bf16 v[132:135], v[24:27], v[76:79], v[132:135]
    ds_read_b64_tr_b16 v[52:53], v93 offset:256
    v_mfma_f32_16x16x32_bf16 v[136:139], v[24:27], v[80:83], v[136:139]
    ds_read_b64_tr_b16 v[54:55], v93 offset:4864
    v_mfma_f32_16x16x32_bf16 v[140:143], v[24:27], v[84:87], v[140:143]
    s_add_u32 s64, s64, 36864
    s_waitcnt lgkmcnt(12)
    v_mfma_f32_16x16x32_bf16 v[144:147], v[28:31], v[72:75], v[144:147]
    s_cmp_eq_u32 s64, 110592
    v_mfma_f32_16x16x32_bf16 v[148:151], v[28:31], v[76:79], v[148:151]
    s_cselect_b32 s64, 0, s64
    v_mfma_f32_16x16x32_bf16 v[152:155], v[28:31], v[80:83], v[152:155]
    s_add_u32 s66, s66, 1
    v_mfma_f32_16x16x32_bf16 v[156:159], v[28:31], v[84:87], v[156:159]
    v_add_u32 v92, s64, v88
    s_waitcnt lgkmcnt(10)
    v_mfma_f32_16x16x32_bf16 v[160:163], v[32:35], v[72:75], v[160:163]
    v_add_u32 v93, s64, v89
    v_mfma_f32_16x16x32_bf16 v[164:167], v[32:35], v[76:79], v[164:167]
    v_add_u32 v94, s64, v90
    v_mfma_f32_16x16x32_bf16 v[168:171], v[32:35], v[80:83], v[168:171]
    v_add_u32 v95, s64, v91
    v_mfma_f32_16x16x32_bf16 v[172:175], v[32:35], v[84:87], v[172:175]
    s_add_u32 s65, s65, 8192
    s_waitcnt lgkmcnt(8)
    v_mfma_f32_16x16x32_bf16 v[176:179], v[36:39], v[72:75], v[176:179]
    s_and_b32 s65, s65, 32767
    v_mfma_f32_16x16x32_bf16 v[180:183], v[36:39], v[76:79], v[180:183]
    v_add_u32 v3, s65, v1
    v_mfma_f32_16x16x32_bf16 v[184:187], v[36:39], v[80:83], v[184:187]
    v_add_u32 v4, s65, v2
    v_mfma_f32_16x16x32_bf16 v[188:191], v[36:39], v[84:87], v[188:191]
    s_waitcnt lgkmcnt(6)
    v_mfma_f32_16x16x32_bf16 v[192:195], v[40:43], v[72:75], v[192:195]
    v_mfma_f32_16x16x32_bf16 v[196:199], v[40:43], v[76:79], v[196:199]
    v_mfma_f32_16x16x32_bf16 v[200:203], v[40:43], v[80:83], v[200:203]
    v_mfma_f32_16x16x32_bf16 v[204:207], v[40:43], v[84:87], v[204:207]
    s_waitcnt lgkmcnt(0)
    s_branch MAL
MAX:
    s_barrier
    ds_read_b64_tr_b16 v[16:17], v92 offset:0
    v_mfma_f32_16x16x32_bf16 v[208:211], v[44:47], v[56:59], v[208:211]
    ds_read_b64_tr_b16 v[18:19], v92 offset:4608
    v_mfma_f32_16x16x32_bf16 v[212:215], v[44:47], v[60:63], v[212:215]
    ds_read_b128 v[72:75], v4 offset:0
    v_mfma_f32_16x16x32_bf16 v[216:219], v[44:47], v[64:67], v[216:219]
    ds_read_b128 v[76:79], v4 offset:2048
    v_mfma_f32_16x16x32_bf16 v[220:223], v[44:47], v[68:71], v[220:223]
    ds_read_b128 v[80:83], v4 offset:4096
    v_mfma_f32_16x16x32_bf16 v[224:227], v[48:51], v[56:59], v[224:227]
    ds_read_b128 v[84:87], v4 offset:6144
    v_mfma_f32_16x16x32_bf16 v[228:231], v[48:51], v[60:63], v[228:231]
    ds_read_b64_tr_b16 v[20:21], v93 offset:0
    v_mfma_f32_16x16x32_bf16 v[232:235], v[48:51], v[64:67], v[232:235]
    ds_read_b64_tr_b16 v[22:23], v93 offset:4608
    v_mfma_f32_16x16x32_bf16 v[236:239], v[48:51], v[68:71], v[236:239]
    ds_read_b64_tr_b16 v[24:25], v94 offset:0
    v_mfma_f32_16x16x32_bf16 v[240:243], v[52:55], v[56:59], v[240:243]
    ds_read_b64_tr_b16 v[26:27], v94 offset:4608
    v_mfma_f32_16x16x32_bf16 v[244:247], v[52:55], v[60:63], v[244:247]
    ds_read_b64_tr_b16 v[28:29], v95 offset:0
    v_mfma_f32_16x16x32_bf16 v[248:251], v[52:55], v[64:67], v[248:251]
    ds_read_b64_tr_b16 v[30:31], v95 offset:4608
    v_mfma_f32_16x16x32_bf16 v[252:255], v[52:55], v[68:71], v[252:255]
    ds_read_b64_tr_b16 v[32:33], v92 offset:128
    s_waitcnt lgkmcnt(10)
    v_mfma_f32_16x16x32_bf16 v[96:99], v[16:19], v[72:75], v[96:99]
    ds_read_b64_tr_b16 v[34:35], v92 offset:4736
    s_waitcnt lgkmcnt(10)
    v_mfma_f32_16x16x32_bf16 v[100:103], v[16:19], v[76:79], v[100:103]
    ds_read_b64_tr_b16 v[36:37], v93 offset:128
    s_waitcnt lgkmcnt(10)
    v_mfma_f32_16x16x32_bf16 v[104:107], v[16:19], v[80:83], v[104:107]
    ds_read_b64_tr_b16 v[38:39], v93 offset:4736
    s_waitcnt lgkmcnt(10)
    v_mfma_f32_16x16x32_bf16 v[108:111], v[16:19], v[84:87], v[108:111]
    ds_read_b64_tr_b16 v[40:41], v94 offset:128
    s_waitcnt lgkmcnt(9)
    v_mfma_f32_16x16x32_bf16 v[112:115], v[20:23], v[72:75], v[112:115]
    ds_read_b64_tr_b16 v[42:43], v94 offset:4736
    v_mfma_f32_16x16x32_bf16 v[116:119], v[20:23], v[76:79], v[116:119]
    ds_read_b64_tr_b16 v[44:45], v95 offset:128
    v_mfma_f32_16x16x32_bf16 v[120:123], v[20:23], v[80:83], v[120:123]
    ds_read_b64_tr_b16 v[46:47], v95 offset:4736
    v_mfma_f32_16x16x32_bf16 v[124:127], v[20:23], v[84:87], v[124:127]
    ds_read_b64_tr_b16 v[48:49], v92 offset:256
    s_waitcnt lgkmcnt(11)
    v_mfma_f32_16x16x32_bf16 v[128:131], v[24:27], v[72:75], v[128:131]
    ds_read_b64_tr_b16 v[50:51], v92 offset:4864
    v_mfma_f32_16x16x32_bf16 v[132:135], v[24:27], v[76:79], v[132:135]
    ds_read_b64_tr_b16 v[52:53], v93 offset:256
    v_mfma_f32_16x16x32_bf16 v[136:139], v[24:27], v[80:83], v[136:139]
    ds_read_b64_tr_b16 v[54:55], v93 offset:4864
    v_mfma_f32_16x16x32_bf16 v[140:143], v[24:27], v[84:87], v[140:143]
    v_cvt_pk_bf16_f32 v96, v96, v97
    v_cvt_pk_bf16_f32 v97, v98, v99
    s_waitcnt lgkmcnt(12)
    v_mfma_f32_16x16x32_bf16 v[144:147], v[28:31], v[72:75], v[144:147]
    v_cvt_pk_bf16_f32 v98, v112, v113
    v_cvt_pk_bf16_f32 v99, v114, v115
    v_mfma_f32_16x16x32_bf16 v[148:151], v[28:31], v[76:79], v[148:151]
    v_pk_max_i16 v96, v96, 0
    v_pk_max_i16 v97, v97, 0
    v_mfma_f32_16x16x32_bf16 v[152:155], v[28:31], v[80:83], v[152:155]
    v_pk_max_i16 v98, v98, 0
    v_pk_max_i16 v99, v99, 0
    v_mfma_f32_16x16x32_bf16 v[156:159], v[28:31], v[84:87], v[156:159]
    s_waitcnt lgkmcnt(10)
    v_mfma_f32_16x16x32_bf16 v[160:163], v[32:35], v[72:75], v[160:163]
    s_waitcnt lgkmcnt(0)
    s_barrier
    ds_write_b128 v8, v[96:99] offset:0
    v_cvt_pk_bf16_f32 v100, v100, v101
    v_mfma_f32_16x16x32_bf16 v[164:167], v[32:35], v[76:79], v[164:167]
    v_cvt_pk_bf16_f32 v101, v102, v103
    v_cvt_pk_bf16_f32 v102, v116, v117
    v_mfma_f32_16x16x32_bf16 v[168:171], v[32:35], v[80:83], v[168:171]
    v_cvt_pk_bf16_f32 v103, v118, v119
    v_pk_max_i16 v100, v100, 0
    v_mfma_f32_16x16x32_bf16 v[172:175], v[32:35], v[84:87], v[172:175]
    v_pk_max_i16 v101, v101, 0
    v_pk_max_i16 v102, v102, 0
    v_mfma_f32_16x16x32_bf16 v[176:179], v[36:39], v[72:75], v[176:179]
    v_pk_max_i16 v103, v103, 0
    ds_write_b128 v8, v[100:103] offset:1024
    v_mfma_f32_16x16x32_bf16 v[180:183], v[36:39], v[76:79], v[180:183]
    v_cvt_pk_bf16_f32 v104, v104, v105
    v_cvt_pk_bf16_f32 v105, v106, v107
    v_mfma_f32_16x16x32_bf16 v[184:187], v[36:39], v[80:83], v[184:187]
    v_cvt_pk_bf16_f32 v106, v120, v121
    v_cvt_pk_bf16_f32 v107, v122, v123
    v_mfma_f32_16x16x32_bf16 v[188:191], v[36:39], v[84:87], v[188:191]
    v_pk_max_i16 v104, v104, 0
    v_pk_max_i16 v105, v105, 0
    v_mfma_f32_16x16x32_bf16 v[192:195], v[40:43], v[72:75], v[192:195]
    v_pk_max_i16 v106, v106, 0
    v_pk_max_i16 v107, v107, 0
    v_mfma_f32_16x16x32_bf16 v[196:199], v[40:43], v[76:79], v[196:199]
    ds_write_b128 v8, v[104:107] offset:2048
    v_cvt_pk_bf16_f32 v108, v108, v109
    v_mfma_f32_16x16x32_bf16 v[200:203], v[40:43], v[80:83], v[200:203]
    v_cvt_pk_bf16_f32 v109, v110, v111
    v_cvt_pk_bf16_f32 v110, v124, v125
    v_mfma_f32_16x16x32_bf16 v[204:207], v[40:43], v[84:87], v[204:207]
    v_cvt_pk_bf16_f32 v111, v126, v127
    v_pk_max_i16 v108, v108, 0
    v_mfma_f32_16x16x32_bf16 v[208:211], v[44:47], v[72:75], v[208:211]
    v_pk_max_i16 v109, v109, 0
    v_pk_max_i16 v110, v110, 0
    v_mfma_f32_16x16x32_bf16 v[212:215], v[44:47], v[76:79], v[212:215]
    v_pk_max_i16 v111, v111, 0
    ds_write_b128 v8, v[108:111] offset:3072
    v_mfma_f32_16x16x32_bf16 v[216:219], v[44:47], v[80:83], v[216:219]
    v_cvt_pk_bf16_f32 v128, v128, v129
    v_cvt_pk_bf16_f32 v129, v130, v131
    v_mfma_f32_16x16x32_bf16 v[220:223], v[44:47], v[84:87], v[220:223]
    v_cvt_pk_bf16_f32 v130, v144, v145
    v_cvt_pk_bf16_f32 v131, v146, v147
    v_mfma_f32_16x16x32_bf16 v[224:227], v[48:51], v[72:75], v[224:227]
    v_pk_max_i16 v128, v128, 0
    v_pk_max_i16 v129, v129, 0
    v_mfma_f32_16x16x32_bf16 v[228:231], v[48:51], v[76:79], v[228:231]
    v_pk_max_i16 v130, v130, 0
    v_pk_max_i16 v131, v131, 0
    v_mfma_f32_16x16x32_bf16 v[232:235], v[48:51], v[80:83], v[232:235]
    ds_write_b128 v8, v[128:131] offset:4096
    v_cvt_pk_bf16_f32 v132, v132, v133
    v_mfma_f32_16x16x32_bf16 v[236:239], v[48:51], v[84:87], v[236:239]
    v_cvt_pk_bf16_f32 v133, v134, v135
    v_cvt_pk_bf16_f32 v134, v148, v149
    v_mfma_f32_16x16x32_bf16 v[240:243], v[52:55], v[72:75], v[240:243]
    v_cvt_pk_bf16_f32 v135, v150, v151
    v_pk_max_i16 v132, v132, 0
    v_mfma_f32_16x16x32_bf16 v[244:247], v[52:55], v[76:79], v[244:247]
    v_pk_max_i16 v133, v133, 0
    v_pk_max_i16 v134, v134, 0
    v_mfma_f32_16x16x32_bf16 v[248:251], v[52:55], v[80:83], v[248:251]
    v_pk_max_i16 v135, v135, 0
    ds_write_b128 v8, v[132:135] offset:5120
    v_mfma_f32_16x16x32_bf16 v[252:255], v[52:55], v[84:87], v[252:255]
    v_cvt_pk_bf16_f32 v136, v136, v137
    v_cvt_pk_bf16_f32 v137, v138, v139
    v_cvt_pk_bf16_f32 v138, v152, v153
    v_cvt_pk_bf16_f32 v139, v154, v155
    v_pk_max_i16 v136, v136, 0
    v_pk_max_i16 v137, v137, 0
    v_pk_max_i16 v138, v138, 0
    v_pk_max_i16 v139, v139, 0
    ds_write_b128 v8, v[136:139] offset:6144
    v_cvt_pk_bf16_f32 v140, v140, v141
    v_cvt_pk_bf16_f32 v141, v142, v143
    v_cvt_pk_bf16_f32 v142, v156, v157
    v_cvt_pk_bf16_f32 v143, v158, v159
    v_pk_max_i16 v140, v140, 0
    v_pk_max_i16 v141, v141, 0
    v_pk_max_i16 v142, v142, 0
    v_pk_max_i16 v143, v143, 0
    ds_write_b128 v8, v[140:143] offset:7168
    v_cvt_pk_bf16_f32 v160, v160, v161
    v_cvt_pk_bf16_f32 v161, v162, v163
    v_cvt_pk_bf16_f32 v162, v176, v177
    v_cvt_pk_bf16_f32 v163, v178, v179
    v_pk_max_i16 v160, v160, 0
    v_pk_max_i16 v161, v161, 0
    v_pk_max_i16 v162, v162, 0
    v_pk_max_i16 v163, v163, 0
    ds_write_b128 v8, v[160:163] offset:8192
    v_cvt_pk_bf16_f32 v164, v164, v165
    v_cvt_pk_bf16_f32 v165, v166, v167
    v_cvt_pk_bf16_f32 v166, v180, v181
    v_cvt_pk_bf16_f32 v167, v182, v183
    v_pk_max_i16 v164, v164, 0
    v_pk_max_i16 v165, v165, 0
    v_pk_max_i16 v166, v166, 0
    v_pk_max_i16 v167, v167, 0
    ds_write_b128 v8, v[164:167] offset:9216
    v_cvt_pk_bf16_f32 v168, v168, v169
    v_cvt_pk_bf16_f32 v169, v170, v171
    v_cvt_pk_bf16_f32 v170, v184, v185
    v_cvt_pk_bf16_f32 v171, v186, v187
    v_pk_max_i16 v168, v168, 0
    v_pk_max_i16 v169, v169, 0
    v_pk_max_i16 v170, v170, 0
    v_pk_max_i16 v171, v171, 0
    ds_write_b128 v8, v[168:171] offset:10240
    v_cvt_pk_bf16_f32 v172, v172, v173
    v_cvt_pk_bf16_f32 v173, v174, v175
    v_cvt_pk_bf16_f32 v174, v188, v189
    v_cvt_pk_bf16_f32 v175, v190, v191
    v_pk_max_i16 v172, v172, 0
    v_pk_max_i16 v173, v173, 0
    v_pk_max_i16 v174, v174, 0
    v_pk_max_i16 v175, v175, 0
    ds_write_b128 v8, v[172:175] offset:11264
    v_cvt_pk_bf16_f32 v192, v192, v193
    v_cvt_pk_bf16_f32 v193, v194, v195
    v_cvt_pk_bf16_f32 v194, v208, v209
    v_cvt_pk_bf16_f32 v195, v210, v211
    v_pk_max_i16 v192, v192, 0
    v_pk_max_i16 v193, v193, 0
    v_pk_max_i16 v194, v194, 0
    v_pk_max_i16 v195, v195, 0
    ds_write_b128 v8, v[192:195] offset:12288
    v_cvt_pk_bf16_f32 v196, v196, v197
    v_cvt_pk_bf16_f32 v197, v198, v199
    v_cvt_pk_bf16_f32 v198, v212, v213
    v_cvt_pk_bf16_f32 v199, v214, v215
    v_pk_max_i16 v196, v196, 0
    v_pk_max_i16 v197, v197, 0
    v_pk_max_i16 v198, v198, 0
    v_pk_max_i16 v199, v199, 0
    ds_write_b128 v8, v[196:199] offset:13312
    v_cvt_pk_bf16_f32 v200, v200, v201
    v_cvt_pk_bf16_f32 v201, v202, v203
    v_cvt_pk_bf16_f32 v202, v216, v217
    v_cvt_pk_bf16_f32 v203, v218, v219
    v_pk_max_i16 v200, v200, 0
    v_pk_max_i16 v201, v201, 0
    v_pk_max_i16 v202, v202, 0
    v_pk_max_i16 v203, v203, 0
    ds_write_b128 v8, v[200:203] offset:14336
    v_cvt_pk_bf16_f32 v204, v204, v205
    v_cvt_pk_bf16_f32 v205, v206, v207
    v_cvt_pk_bf16_f32 v206, v220, v221
    v_cvt_pk_bf16_f32 v207, v222, v223
    v_pk_max_i16 v204, v204, 0
    v_pk_max_i16 v205, v205, 0
    v_pk_max_i16 v206, v206, 0
    v_pk_max_i16 v207, v207, 0
    ds_write_b128 v8, v[204:207] offset:15360
    v_cvt_pk_bf16_f32 v224, v224, v225
    v_cvt_pk_bf16_f32 v225, v226, v227
    v_cvt_pk_bf16_f32 v226, v240, v241
    v_cvt_pk_bf16_f32 v227, v242, v243
    v_pk_max_i16 v224, v224, 0
    v_pk_max_i16 v225, v225, 0
    v_pk_max_i16 v226, v226, 0
    v_pk_max_i16 v227, v227, 0
    ds_write_b128 v8, v[224:227] offset:16384
    v_cvt_pk_bf16_f32 v228, v228, v229
    v_cvt_pk_bf16_f32 v229, v230, v231
    v_cvt_pk_bf16_f32 v230, v244, v245
    v_cvt_pk_bf16_f32 v231, v246, v247
    v_pk_max_i16 v228, v228, 0
    v_pk_max_i16 v229, v229, 0
    v_pk_max_i16 v230, v230, 0
    v_pk_max_i16 v231, v231, 0
    ds_write_b128 v8, v[228:231] offset:17408
    v_cvt_pk_bf16_f32 v232, v232, v233
    v_cvt_pk_bf16_f32 v233, v234, v235
    v_cvt_pk_bf16_f32 v234, v248, v249
    v_cvt_pk_bf16_f32 v235, v250, v251
    v_pk_max_i16 v232, v232, 0
    v_pk_max_i16 v233, v233, 0
    v_pk_max_i16 v234, v234, 0
    v_pk_max_i16 v235, v235, 0
    ds_write_b128 v8, v[232:235] offset:18432
    v_cvt_pk_bf16_f32 v236, v236, v237
    v_cvt_pk_bf16_f32 v237, v238, v239
    v_cvt_pk_bf16_f32 v238, v252, v253
    v_cvt_pk_bf16_f32 v239, v254, v255
    v_pk_max_i16 v236, v236, 0
    v_pk_max_i16 v237, v237, 0
    v_pk_max_i16 v238, v238, 0
    v_pk_max_i16 v239, v239, 0
    ds_write_b128 v8, v[236:239] offset:19456
    s_branch M1_J
MBL:
    s_barrier
    ds_read_b64_tr_b16 v[16:17], v92 offset:0
    v_mfma_f32_16x16x32_bf16 v[176:179], v[36:39], v[72:75], v[176:179]
    ds_read_b64_tr_b16 v[18:19], v92 offset:4608
    v_mfma_f32_16x16x32_bf16 v[180:183], v[36:39], v[76:79], v[180:183]
    ds_read_b128 v[56:59], v3 offset:0
    v_mfma_f32_16x16x32_bf16 v[184:187], v[36:39], v[80:83], v[184:187]
    ds_read_b128 v[60:63], v3 offset:2048
    v_mfma_f32_16x16x32_bf16 v[188:191], v[36:39], v[84:87], v[188:191]
    ds_read_b128 v[64:67], v3 offset:4096
    v_mfma_f32_16x16x32_bf16 v[192:195], v[40:43], v[72:75], v[192:195]
    ds_read_b128 v[68:71], v3 offset:6144
    v_mfma_f32_16x16x32_bf16 v[196:199], v[40:43], v[76:79], v[196:199]
    ds_read_b64_tr_b16 v[20:21], v93 offset:0
    v_mfma_f32_16x16x32_bf16 v[200:203], v[40:43], v[80:83], v[200:203]
    ds_read_b64_tr_b16 v[22:23], v93 offset:4608
    v_mfma_f32_16x16x32_bf16 v[204:207], v[40:43], v[84:87], v[204:207]
    ds_read_b64_tr_b16 v[24:25], v94 offset:0
    v_mfma_f32_16x16x32_bf16 v[208:211], v[44:47], v[72:75], v[208:211]
    ds_read_b64_tr_b16 v[26:27], v94 offset:4608
    v_mfma_f32_16x16x32_bf16 v[212:215], v[44:47], v[76:79], v[212:215]
    ds_read_b64_tr_b16 v[28:29], v95 offset:0
    v_mfma_f32_16x16x32_bf16 v[216:219], v[44:47], v[80:83], v[216:219]
    ds_read_b64_tr_b16 v[30:31], v95 offset:4608
    v_mfma_f32_16x16x32_bf16 v[220:223], v[44:47], v[84:87], v[220:223]
    ds_read_b64_tr_b16 v[32:33], v92 offset:128
    s_waitcnt lgkmcnt(10)
    v_mfma_f32_16x16x32_bf16 v[96:99], v[16:19], v[56:59], v[96:99]
    ds_read_b64_tr_b16 v[34:35], v92 offset:4736
    s_waitcnt lgkmcnt(10)
    v_mfma_f32_16x16x32_bf16 v[100:103], v[16:19], v[60:63], v[100:103]
    ds_read_b64_tr_b16 v[36:37], v93 offset:128
    s_waitcnt lgkmcnt(10)
    v_mfma_f32_16x16x32_bf16 v[104:107], v[16:19], v[64:67], v[104:107]
    ds_read_b64_tr_b16 v[38:39], v93 offset:4736
    s_waitcnt lgkmcnt(10)
    v_mfma_f32_16x16x32_bf16 v[108:111], v[16:19], v[68:71], v[108:111]
    ds_read_b64_tr_b16 v[40:41], v94 offset:128
    s_waitcnt lgkmcnt(9)
    v_mfma_f32_16x16x32_bf16 v[112:115], v[20:23], v[56:59], v[112:115]
    ds_read_b64_tr_b16 v[42:43], v94 offset:4736
    v_mfma_f32_16x16x32_bf16 v[116:119], v[20:23], v[60:63], v[116:119]
    ds_read_b64_tr_b16 v[44:45], v95 offset:128
    v_mfma_f32_16x16x32_bf16 v[120:123], v[20:23], v[64:67], v[120:123]
    ds_read_b64_tr_b16 v[46:47], v95 offset:4736
    v_mfma_f32_16x16x32_bf16 v[124:127], v[20:23], v[68:71], v[124:127]
    s_add_u32 s64, s64, 36864
    s_waitcnt lgkmcnt(10)
    v_mfma_f32_16x16x32_bf16 v[128:131], v[24:27], v[56:59], v[128:131]
    s_cmp_eq_u32 s64, 110592
    v_mfma_f32_16x16x32_bf16 v[132:135], v[24:27], v[60:63], v[132:135]
    s_cselect_b32 s64, 0, s64
    v_mfma_f32_16x16x32_bf16 v[136:139], v[24:27], v[64:67], v[136:139]
    s_add_u32 s66, s66, 1
    v_mfma_f32_16x16x32_bf16 v[140:143], v[24:27], v[68:71], v[140:143]
    v_add_u32 v92, s64, v88
    s_waitcnt lgkmcnt(8)
    v_mfma_f32_16x16x32_bf16 v[144:147], v[28:31], v[56:59], v[144:147]
    v_add_u32 v93, s64, v89
    v_mfma_f32_16x16x32_bf16 v[148:151], v[28:31], v[60:63], v[148:151]
    v_add_u32 v94, s64, v90
    v_mfma_f32_16x16x32_bf16 v[152:155], v[28:31], v[64:67], v[152:155]
    v_add_u32 v95, s64, v91
    v_mfma_f32_16x16x32_bf16 v[156:159], v[28:31], v[68:71], v[156:159]
    s_cmp_eq_u32 s66, 18
    s_waitcnt lgkmcnt(6)
    v_mfma_f32_16x16x32_bf16 v[160:163], v[32:35], v[56:59], v[160:163]
    v_mfma_f32_16x16x32_bf16 v[164:167], v[32:35], v[60:63], v[164:167]
    v_mfma_f32_16x16x32_bf16 v[168:171], v[32:35], v[64:67], v[168:171]
    v_mfma_f32_16x16x32_bf16 v[172:175], v[32:35], v[68:71], v[172:175]
    s_waitcnt lgkmcnt(0)
    s_cbranch_scc1 MBX
    s_barrier
    ds_read_b64_tr_b16 v[16:17], v92 offset:0
    v_mfma_f32_16x16x32_bf16 v[176:179], v[36:39], v[56:59], v[176:179]
    ds_read_b64_tr_b16 v[18:19], v92 offset:4608
    v_mfma_f32_16x16x32_bf16 v[180:183], v[36:39], v[60:63], v[180:183]
    ds_read_b128 v[72:75], v4 offset:0
    v_mfma_f32_16x16x32_bf16 v[184:187], v[36:39], v[64:67], v[184:187]
    ds_read_b128 v[76:79], v4 offset:2048
    v_mfma_f32_16x16x32_bf16 v[188:191], v[36:39], v[68:71], v[188:191]
    ds_read_b128 v[80:83], v4 offset:4096
    v_mfma_f32_16x16x32_bf16 v[192:195], v[40:43], v[56:59], v[192:195]
    ds_read_b128 v[84:87], v4 offset:6144
    v_mfma_f32_16x16x32_bf16 v[196:199], v[40:43], v[60:63], v[196:199]
    ds_read_b64_tr_b16 v[20:21], v93 offset:0
    v_mfma_f32_16x16x32_bf16 v[200:203], v[40:43], v[64:67], v[200:203]
    ds_read_b64_tr_b16 v[22:23], v93 offset:4608
    v_mfma_f32_16x16x32_bf16 v[204:207], v[40:43], v[68:71], v[204:207]
    ds_read_b64_tr_b16 v[24:25], v94 offset:0
    v_mfma_f32_16x16x32_bf16 v[208:211], v[44:47], v[56:59], v[208:211]
    ds_read_b64_tr_b16 v[26:27], v94 offset:4608
    v_mfma_f32_16x16x32_bf16 v[212:215], v[44:47], v[60:63], v[212:215]
    ds_read_b64_tr_b16 v[28:29], v95 offset:0
    v_mfma_f32_16x16x32_bf16 v[216:219], v[44:47], v[64:67], v[216:219]
    ds_read_b64_tr_b16 v[30:31], v95 offset:4608
    v_mfma_f32_16x16x32_bf16 v[220:223], v[44:47], v[68:71], v[220:223]
    ds_read_b64_tr_b16 v[32:33], v92 offset:128
    s_waitcnt lgkmcnt(10)
    v_mfma_f32_16x16x32_bf16 v[96:99], v[16:19], v[72:75], v[96:99]
    ds_read_b64_tr_b16 v[34:35], v92 offset:4736
    s_waitcnt lgkmcnt(10)
    v_mfma_f32_16x16x32_bf16 v[100:103], v[16:19], v[76:79], v[100:103]
    ds_read_b64_tr_b16 v[36:37], v93 offset:128
    s_waitcnt lgkmcnt(10)
    v_mfma_f32_16x16x32_bf16 v[104:107], v[16:19], v[80:83], v[104:107]
    ds_read_b64_tr_b16 v[38:39], v93 offset:4736
    s_waitcnt lgkmcnt(10)
    v_mfma_f32_16x16x32_bf16 v[108:111], v[16:19], v[84:87], v[108:111]
    ds_read_b64_tr_b16 v[40:41], v94 offset:128
    s_waitcnt lgkmcnt(9)
    v_mfma_f32_16x16x32_bf16 v[112:115], v[20:23], v[72:75], v[112:115]
    ds_read_b64_tr_b16 v[42:43], v94 offset:4736
    v_mfma_f32_16x16x32_bf16 v[116:119], v[20:23], v[76:79], v[116:119]
    ds_read_b64_tr_b16 v[44:45], v95 offset:128
    v_mfma_f32_16x16x32_bf16 v[120:123], v[20:23], v[80:83], v[120:123]
    ds_read_b64_tr_b16 v[46:47], v95 offset:4736
    v_mfma_f32_16x16x32_bf16 v[124:127], v[20:23], v[84:87], v[124:127]
    s_add_u32 s64, s64, 36864
    s_waitcnt lgkmcnt(10)
    v_mfma_f32_16x16x32_bf16 v[128:131], v[24:27], v[72:75], v[128:131]
    s_cmp_eq_u32 s64, 110592
    v_mfma_f32_16x16x32_bf16 v[132:135], v[24:27], v[76:79], v[132:135]
    s_cselect_b32 s64, 0, s64
    v_mfma_f32_16x16x32_bf16 v[136:139], v[24:27], v[80:83], v[136:139]
    s_add_u32 s66, s66, 1
    v_mfma_f32_16x16x32_bf16 v[140:143], v[24:27], v[84:87], v[140:143]
    v_add_u32 v92, s64, v88
    s_waitcnt lgkmcnt(8)
    v_mfma_f32_16x16x32_bf16 v[144:147], v[28:31], v[72:75], v[144:147]
    v_add_u32 v93, s64, v89
    v_mfma_f32_16x16x32_bf16 v[148:151], v[28:31], v[76:79], v[148:151]
    v_add_u32 v94, s64, v90
    v_mfma_f32_16x16x32_bf16 v[152:155], v[28:31], v[80:83], v[152:155]
    v_add_u32 v95, s64, v91
    v_mfma_f32_16x16x32_bf16 v[156:159], v[28:31], v[84:87], v[156:159]
    s_add_u32 s65, s65, 8192
    s_waitcnt lgkmcnt(6)
    v_mfma_f32_16x16x32_bf16 v[160:163], v[32:35], v[72:75], v[160:163]
    s_and_b32 s65, s65, 32767
    v_mfma_f32_16x16x32_bf16 v[164:167], v[32:35], v[76:79], v[164:167]
    v_add_u32 v3, s65, v1
    v_mfma_f32_16x16x32_bf16 v[168:171], v[32:35], v[80:83], v[168:171]
    v_add_u32 v4, s65, v2
    v_mfma_f32_16x16x32_bf16 v[172:175], v[32:35], v[84:87], v[172:175]
    s_waitcnt lgkmcnt(0)
    s_branch MBL
MBX:
    s_barrier
    ds_read_b64_tr_b16 v[16:17], v92 offset:0
    v_mfma_f32_16x16x32_bf16 v[176:179], v[36:39], v[56:59], v[176:179]
    ds_read_b64_tr_b16 v[18:19], v92 offset:4608
    v_mfma_f32_16x16x32_bf16 v[180:183], v[36:39], v[60:63], v[180:183]
    ds_read_b128 v[72:75], v4 offset:0
    v_mfma_f32_16x16x32_bf16 v[184:187], v[36:39], v[64:67], v[184:187]
    ds_read_b128 v[76:79], v4 offset:2048
    v_mfma_f32_16x16x32_bf16 v[188:191], v[36:39], v[68:71], v[188:191]
    ds_read_b128 v[80:83], v4 offset:4096
    v_mfma_f32_16x16x32_bf16 v[192:195], v[40:43], v[56:59], v[192:195]
    ds_read_b128 v[84:87], v4 offset:6144
    v_mfma_f32_16x16x32_bf16 v[196:199], v[40:43], v[60:63], v[196:199]
    ds_read_b64_tr_b16 v[20:21], v93 offset:0
    v_mfma_f32_16x16x32_bf16 v[200:203], v[40:43], v[64:67], v[200:203]
    ds_read_b64_tr_b16 v[22:23], v93 offset:4608
    v_mfma_f32_16x16x32_bf16 v[204:207], v[40:43], v[68:71], v[204:207]
    ds_read_b64_tr_b16 v[24:25], v94 offset:0
    v_mfma_f32_16x16x32_bf16 v[208:211], v[44:47], v[56:59], v[208:211]
    ds_read_b64_tr_b16 v[26:27], v94 offset:4608
    v_mfma_f32_16x16x32_bf16 v[212:215], v[44:47], v[60:63], v[212:215]
    ds_read_b64_tr_b16 v[28:29], v95 offset:0
    v_mfma_f32_16x16x32_bf16 v[216:219], v[44:47], v[64:67], v[216:219]
    ds_read_b64_tr_b16 v[30:31], v95 offset:4608
    v_mfma_f32_16x16x32_bf16 v[220:223], v[44:47], v[68:71], v[220:223]
    ds_read_b64_tr_b16 v[32:33], v92 offset:128
    s_waitcnt lgkmcnt(10)
    v_mfma_f32_16x16x32_bf16 v[96:99], v[16:19], v[72:75], v[96:99]
    ds_read_b64_tr_b16 v[34:35], v92 offset:4736
    s_waitcnt lgkmcnt(10)
    v_mfma_f32_16x16x32_bf16 v[100:103], v[16:19], v[76:79], v[100:103]
    ds_read_b64_tr_b16 v[36:37], v93 offset:128
    s_waitcnt lgkmcnt(10)
    v_mfma_f32_16x16x32_bf16 v[104:107], v[16:19], v[80:83], v[104:107]
    ds_read_b64_tr_b16 v[38:39], v93 offset:4736
    s_waitcnt lgkmcnt(10)
    v_mfma_f32_16x16x32_bf16 v[108:111], v[16:19], v[84:87], v[108:111]
    ds_read_b64_tr_b16 v[40:41], v94 offset:128
    s_waitcnt lgkmcnt(9)
    v_mfma_f32_16x16x32_bf16 v[112:115], v[20:23], v[72:75], v[112:115]
    ds_read_b64_tr_b16 v[42:43], v94 offset:4736
    v_mfma_f32_16x16x32_bf16 v[116:119], v[20:23], v[76:79], v[116:119]
    ds_read_b64_tr_b16 v[44:45], v95 offset:128
    v_mfma_f32_16x16x32_bf16 v[120:123], v[20:23], v[80:83], v[120:123]
    ds_read_b64_tr_b16 v[46:47], v95 offset:4736
    v_mfma_f32_16x16x32_bf16 v[124:127], v[20:23], v[84:87], v[124:127]
    s_waitcnt lgkmcnt(10)
    v_mfma_f32_16x16x32_bf16 v[128:131], v[24:27], v[72:75], v[128:131]
    v_mfma_f32_16x16x32_bf16 v[132:135], v[24:27], v[76:79], v[132:135]
    v_mfma_f32_16x16x32_bf16 v[136:139], v[24:27], v[80:83], v[136:139]
    v_mfma_f32_16x16x32_bf16 v[140:143], v[24:27], v[84:87], v[140:143]
    v_cvt_pk_bf16_f32 v96, v96, v97
    v_cvt_pk_bf16_f32 v97, v98, v99
    s_waitcnt lgkmcnt(8)
    v_mfma_f32_16x16x32_bf16 v[144:147], v[28:31], v[72:75], v[144:147]
    s_waitcnt lgkmcnt(0)
    s_barrier
    v_cvt_pk_bf16_f32 v98, v112, v113
    v_cvt_pk_bf16_f32 v99, v114, v115
    v_mfma_f32_16x16x32_bf16 v[148:151], v[28:31], v[76:79], v[148:151]
    v_pk_max_i16 v96, v96, 0
    v_pk_max_i16 v97, v97, 0
    v_mfma_f32_16x16x32_bf16 v[152:155], v[28:31], v[80:83], v[152:155]
    v_pk_max_i16 v98, v98, 0
    v_pk_max_i16 v99, v99, 0
    v_mfma_f32_16x16x32_bf16 v[156:159], v[28:31], v[84:87], v[156:159]
    ds_write_b128 v8, v[96:99] offset:0
    v_cvt_pk_bf16_f32 v100, v100, v101
    v_mfma_f32_16x16x32_bf16 v[160:163], v[32:35], v[72:75], v[160:163]
    v_cvt_pk_bf16_f32 v101, v102, v103
    v_cvt_pk_bf16_f32 v102, v116, v117
    v_mfma_f32_16x16x32_bf16 v[164:167], v[32:35], v[76:79], v[164:167]
    v_cvt_pk_bf16_f32 v103, v118, v119
    v_pk_max_i16 v100, v100, 0
    v_mfma_f32_16x16x32_bf16 v[168:171], v[32:35], v[80:83], v[168:171]
    v_pk_max_i16 v101, v101, 0
    v_pk_max_i16 v102, v102, 0
    v_mfma_f32_16x16x32_bf16 v[172:175], v[32:35], v[84:87], v[172:175]
    v_pk_max_i16 v103, v103, 0
    ds_write_b128 v8, v[100:103] offset:1024
    v_mfma_f32_16x16x32_bf16 v[176:179], v[36:39], v[72:75], v[176:179]
    v_cvt_pk_bf16_f32 v104, v104, v105
    v_cvt_pk_bf16_f32 v105, v106, v107
    v_mfma_f32_16x16x32_bf16 v[180:183], v[36:39], v[76:79], v[180:183]
    v_cvt_pk_bf16_f32 v106, v120, v121
    v_cvt_pk_bf16_f32 v107, v122, v123
    v_mfma_f32_16x16x32_bf16 v[184:187], v[36:39], v[80:83], v[184:187]
    v_pk_max_i16 v104, v104, 0
    v_pk_max_i16 v105, v105, 0
    v_mfma_f32_16x16x32_bf16 v[188:191], v[36:39], v[84:87], v[188:191]
    v_pk_max_i16 v106, v106, 0
    v_pk_max_i16 v107, v107, 0
    v_mfma_f32_16x16x32_bf16 v[192:195], v[40:43], v[72:75], v[192:195]
    ds_write_b128 v8, v[104:107] offset:2048
    v_cvt_pk_bf16_f32 v108, v108, v109
    v_mfma_f32_16x16x32_bf16 v[196:199], v[40:43], v[76:79], v[196:199]
    v_cvt_pk_bf16_f32 v109, v110, v111
    v_cvt_pk_bf16_f32 v110, v124, v125
    v_mfma_f32_16x16x32_bf16 v[200:203], v[40:43], v[80:83], v[200:203]
    v_cvt_pk_bf16_f32 v111, v126, v127
    v_pk_max_i16 v108, v108, 0
    v_mfma_f32_16x16x32_bf16 v[204:207], v[40:43], v[84:87], v[204:207]
    v_pk_max_i16 v109, v109, 0
    v_pk_max_i16 v110, v110, 0
    v_mfma_f32_16x16x32_bf16 v[208:211], v[44:47], v[72:75], v[208:211]
    v_pk_max_i16 v111, v111, 0
    ds_write_b128 v8, v[108:111] offset:3072
    v_mfma_f32_16x16x32_bf16 v[212:215], v[44:47], v[76:79], v[212:215]
    v_cvt_pk_bf16_f32 v128, v128, v129
    v_cvt_pk_bf16_f32 v129, v130, v131
    v_mfma_f32_16x16x32_bf16 v[216:219], v[44:47], v[80:83], v[216:219]
    v_cvt_pk_bf16_f32 v130, v144, v145
    v_cvt_pk_bf16_f32 v131, v146, v147
    v_mfma_f32_16x16x32_bf16 v[220:223], v[44:47], v[84:87], v[220:223]
    v_pk_max_i16 v128, v128, 0
    v_pk_max_i16 v129, v129, 0
    v_pk_max_i16 v130, v130, 0
    v_pk_max_i16 v131, v131, 0
    ds_write_b128 v8, v[128:131] offset:4096
    v_cvt_pk_bf16_f32 v132, v132, v133
    v_cvt_pk_bf16_f32 v133, v134, v135
    v_cvt_pk_bf16_f32 v134, v148, v149
    v_cvt_pk_bf16_f32 v135, v150, v151
    v_pk_max_i16 v132, v132, 0
    v_pk_max_i16 v133, v133, 0
    v_pk_max_i16 v134, v134, 0
    v_pk_max_i16 v135, v135, 0
    ds_write_b128 v8, v[132:135] offset:5120
    v_cvt_pk_bf16_f32 v136, v136, v137
    v_cvt_pk_bf16_f32 v137, v138, v139
    v_cvt_pk_bf16_f32 v138, v152, v153
    v_cvt_pk_bf16_f32 v139, v154, v155
    v_pk_max_i16 v136, v136, 0
    v_pk_max_i16 v137, v137, 0
    v_pk_max_i16 v138, v138, 0
    v_pk_max_i16 v139, v139, 0
    ds_write_b128 v8, v[136:139] offset:6144
    v_cvt_pk_bf16_f32 v140, v140, v141
    v_cvt_pk_bf16_f32 v141, v142, v143
    v_cvt_pk_bf16_f32 v142, v156, v157
    v_cvt_pk_bf16_f32 v143, v158, v159
    v_pk_max_i16 v140, v140, 0
    v_pk_max_i16 v141, v141, 0
    v_pk_max_i16 v142, v142, 0
    v_pk_max_i16 v143, v143, 0
    ds_write_b128 v8, v[140:143] offset:7168
    v_cvt_pk_bf16_f32 v160, v160, v161
    v_cvt_pk_bf16_f32 v161, v162, v163
    v_cvt_pk_bf16_f32 v162, v176, v177
    v_cvt_pk_bf16_f32 v163, v178, v179
    v_pk_max_i16 v160, v160, 0
    v_pk_max_i16 v161, v161, 0
    v_pk_max_i16 v162, v162, 0
    v_pk_max_i16 v163, v163, 0
    ds_write_b128 v8, v[160:163] offset:8192
    v_cvt_pk_bf16_f32 v164, v164, v165
    v_cvt_pk_bf16_f32 v165, v166, v167
    v_cvt_pk_bf16_f32 v166, v180, v181
    v_cvt_pk_bf16_f32 v167, v182, v183
    v_pk_max_i16 v164, v164, 0
    v_pk_max_i16 v165, v165, 0
    v_pk_max_i16 v166, v166, 0
    v_pk_max_i16 v167, v167, 0
    ds_write_b128 v8, v[164:167] offset:9216
    v_cvt_pk_bf16_f32 v168, v168, v169
    v_cvt_pk_bf16_f32 v169, v170, v171
    v_cvt_pk_bf16_f32 v170, v184, v185
    v_cvt_pk_bf16_f32 v171, v186, v187
    v_pk_max_i16 v168, v168, 0
    v_pk_max_i16 v169, v169, 0
    v_pk_max_i16 v170, v170, 0
    v_pk_max_i16 v171, v171, 0
    ds_write_b128 v8, v[168:171] offset:10240
    v_cvt_pk_bf16_f32 v172, v172, v173
    v_cvt_pk_bf16_f32 v173, v174, v175
    v_cvt_pk_bf16_f32 v174, v188, v189
    v_cvt_pk_bf16_f32 v175, v190, v191
    v_pk_max_i16 v172, v172, 0
    v_pk_max_i16 v173, v173, 0
    v_pk_max_i16 v174, v174, 0
    v_pk_max_i16 v175, v175, 0
    ds_write_b128 v8, v[172:175] offset:11264
    v_cvt_pk_bf16_f32 v192, v192, v193
    v_cvt_pk_bf16_f32 v193, v194, v195
    v_cvt_pk_bf16_f32 v194, v208, v209
    v_cvt_pk_bf16_f32 v195, v210, v211
    v_pk_max_i16 v192, v192, 0
    v_pk_max_i16 v193, v193, 0
    v_pk_max_i16 v194, v194, 0
    v_pk_max_i16 v195, v195, 0
    ds_write_b128 v8, v[192:195] offset:12288
    v_cvt_pk_bf16_f32 v196, v196, v197
    v_cvt_pk_bf16_f32 v197, v198, v199
    v_cvt_pk_bf16_f32 v198, v212, v213
    v_cvt_pk_bf16_f32 v199, v214, v215
    v_pk_max_i16 v196, v196, 0
    v_pk_max_i16 v197, v197, 0
    v_pk_max_i16 v198, v198, 0
    v_pk_max_i16 v199, v199, 0
    ds_write_b128 v8, v[196:199] offset:13312
    v_cvt_pk_bf16_f32 v200, v200, v201
    v_cvt_pk_bf16_f32 v201, v202, v203
    v_cvt_pk_bf16_f32 v202, v216, v217
    v_cvt_pk_bf16_f32 v203, v218, v219
    v_pk_max_i16 v200, v200, 0
    v_pk_max_i16 v201, v201, 0
    v_pk_max_i16 v202, v202, 0
    v_pk_max_i16 v203, v203, 0
    ds_write_b128 v8, v[200:203] offset:14336
    v_cvt_pk_bf16_f32 v204, v204, v205
    v_cvt_pk_bf16_f32 v205, v206, v207
    v_cvt_pk_bf16_f32 v206, v220, v221
    v_cvt_pk_bf16_f32 v207, v222, v223
    v_pk_max_i16 v204, v204, 0
    v_pk_max_i16 v205, v205, 0
    v_pk_max_i16 v206, v206, 0
    v_pk_max_i16 v207, v207, 0
    ds_write_b128 v8, v[204:207] offset:15360
M1_J:
    s_waitcnt vmcnt(0)
    s_waitcnt lgkmcnt(0)
    v_mov_b32 v100, v9
    v_add_u32 v101, 36864, v9
    s_barrier
    ds_read_b128 v[112:115], v100 offset:0
    ds_read_b128 v[116:119], v100 offset:1024
    ds_read_b128 v[120:123], v100 offset:4096
    ds_read_b128 v[124:127], v100 offset:5120
    ds_read_b128 v[128:131], v100 offset:8192
    ds_read_b128 v[132:135], v100 offset:9216
    ds_read_b128 v[136:139], v100 offset:12288
    ds_read_b128 v[140:143], v100 offset:13312
    ds_read_b128 v[144:147], v100 offset:16384
    ds_read_b128 v[148:151], v100 offset:17408
    ds_read_b128 v[152:155], v100 offset:20480
    ds_read_b128 v[156:159], v100 offset:21504
    ds_read_b128 v[160:163], v100 offset:24576
    ds_read_b128 v[164:167], v100 offset:25600
    ds_read_b128 v[168:171], v100 offset:28672
    ds_read_b128 v[172:175], v100 offset:29696
    ds_read_b128 v[176:179], v100 offset:32768
    ds_read_b128 v[180:183], v100 offset:33792
    ds_read_b128 v[184:187], v101 offset:0
    ds_read_b128 v[188:191], v101 offset:1024
    ds_read_b128 v[192:195], v101 offset:4096
    ds_read_b128 v[196:199], v101 offset:5120
    ds_read_b128 v[200:203], v101 offset:8192
    ds_read_b128 v[204:207], v101 offset:9216
    ds_read_b128 v[208:211], v101 offset:12288
    ds_read_b128 v[212:215], v101 offset:13312
    ds_read_b128 v[216:219], v101 offset:16384
    ds_read_b128 v[220:223], v101 offset:17408
    ds_read_b128 v[224:227], v101 offset:20480
    ds_read_b128 v[228:231], v101 offset:21504
    ds_read_b128 v[232:235], v101 offset:24576
    ds_read_b128 v[236:239], v101 offset:25600
    ds_read_b128 v[240:243], v101 offset:28672
    ds_read_b128 v[244:247], v101 offset:29696
    ds_read_b128 v[248:251], v101 offset:32768
    ds_read_b128 v[252:255], v101 offset:33792
    v_mov_b32 v102, v10
    v_mov_b32 v103, v11
    v_add_u32 v104, 36864, v10
    v_add_u32 v105, 36864, v11
    v_mov_b32 v106, v12
    v_mov_b32 v108, v13
    v_mov_b32 v109, v14
    v_mov_b32 v107, 20
    ds_read_b32 v110, v109
    s_mov_b32 s64, 73728
    s_mov_b32 s65, 0
    s_mov_b32 s66, 19
    s_mul_i32 s60, s2, 73728
    s_lshl_b32 s61, s5, 11
    s_add_u32 s60, s60, s61
    s_mov_b32 s67, 1073741824
    s_lshl_b32 s19, s2, 7
    s_lshl_b32 s61, s5, 2
    s_add_u32 s19, s19, s61
    s_add_u32 s19, s19, 25165824
    s_mov_b32 s63, 648
    v_mov_b32 v6, 0
    s_mov_b32 s62, 63
    s_waitcnt lgkmcnt(0)
    s_barrier
    v_add_u32 v104, s64, v104
    v_add_u32 v105, s64, v105
    s_sub_u32 s64, 0, s64
M2_L:
    s_waitcnt lgkmcnt(6)
    v_cmp_gt_u32 vcc, s66, v110
    s_cbranch_vccnz SP12
SP12R:
    ds_read_b64_tr_b16 v[16:17], v102 offset:0
    v_mfma_f32_16x16x32_bf16 v[80:83], v[40:43], v[232:235], v[80:83]
    ds_read_b64_tr_b16 v[18:19], v102 offset:2048
    v_mfma_f32_16x16x32_bf16 v[84:87], v[40:43], v[236:239], v[84:87]
    ds_read_b64_tr_b16 v[20:21], v103 offset:0
    v_add_u32 v104, s64, v104
    v_mfma_f32_16x16x32_bf16 v[88:91], v[44:47], v[232:235], v[88:91]
    ds_read_b64_tr_b16 v[22:23], v103 offset:2048
    v_add_u32 v105, s64, v105
    v_mfma_f32_16x16x32_bf16 v[92:95], v[44:47], v[236:239], v[92:95]
    ds_read_b64_tr_b16 v[24:25], v102 offset:4096
    s_sub_u32 s64, 0, s64
    v_mfma_f32_16x16x32_bf16 v[80:83], v[48:51], v[240:243], v[80:83]
    ds_read_b64_tr_b16 v[26:27], v102 offset:6144
    s_add_u32 s66, s66, 1
    v_mfma_f32_16x16x32_bf16 v[84:87], v[48:51], v[244:247], v[84:87]
    ds_read_b64_tr_b16 v[28:29], v103 offset:4096
    s_waitcnt lgkmcnt(12)
    v_mfma_f32_16x16x32_bf16 v[88:91], v[52:55], v[240:243], v[88:91]
    ds_read_b64_tr_b16 v[30:31], v103 offset:6144
    v_mfma_f32_16x16x32_bf16 v[92:95], v[52:55], v[244:247], v[92:95]
    ds_read_b64_tr_b16 v[32:33], v102 offset:8192
    s_waitcnt lgkmcnt(12)
    v_mfma_f32_16x16x32_bf16 v[80:83], v[56:59], v[248:251], v[80:83]
    ds_read_b64_tr_b16 v[34:35], v102 offset:10240
    v_mfma_f32_16x16x32_bf16 v[84:87], v[56:59], v[252:255], v[84:87]
    ds_read_b64_tr_b16 v[36:37], v103 offset:8192
    s_waitcnt lgkmcnt(12)
    v_mfma_f32_16x16x32_bf16 v[88:91], v[60:63], v[248:251], v[88:91]
    ds_read_b64_tr_b16 v[38:39], v103 offset:10240
    v_mfma_f32_16x16x32_bf16 v[92:95], v[60:63], v[252:255], v[92:95]
    ds_read_b64_tr_b16 v[40:41], v102 offset:12288
    s_waitcnt lgkmcnt(11)
    v_mfma_f32_16x16x32_bf16 v[64:67], v[16:19], v[112:115], 0
    ds_read_b64_tr_b16 v[42:43], v102 offset:14336
    v_mfma_f32_16x16x32_bf16 v[68:71], v[16:19], v[116:119], 0
    ds_read_b64_tr_b16 v[44:45], v103 offset:12288
    s_waitcnt lgkmcnt(11)
    v_mfma_f32_16x16x32_bf16 v[72:75], v[20:23], v[112:115], 0
    ds_read_b64_tr_b16 v[46:47], v103 offset:14336
    v_mfma_f32_16x16x32_bf16 v[76:79], v[20:23], v[116:119], 0
    ds_read_b64_tr_b16 v[48:49], v102 offset:16384
    v_cvt_pk_bf16_f32 v8, v80, v81
    s_waitcnt lgkmcnt(11)
    v_mfma_f32_16x16x32_bf16 v[64:67], v[24:27], v[120:123], v[64:67]
    ds_read_b64_tr_b16 v[50:51], v102 offset:18432
    v_cvt_pk_bf16_f32 v9, v82, v83
    v_mfma_f32_16x16x32_bf16 v[68:71], v[24:27], v[124:127], v[68:71]
    ds_read_b64_tr_b16 v[52:53], v103 offset:16384
    v_cvt_pk_bf16_f32 v10, v88, v89
    s_waitcnt lgkmcnt(11)
    v_mfma_f32_16x16x32_bf16 v[72:75], v[28:31], v[120:123], v[72:75]
    ds_read_b64_tr_b16 v[54:55], v103 offset:18432
    v_cvt_pk_bf16_f32 v11, v90, v91
    v_mfma_f32_16x16x32_bf16 v[76:79], v[28:31], v[124:127], v[76:79]
    ds_read_b64_tr_b16 v[56:57], v102 offset:20480
    v_cvt_pk_bf16_f32 v12, v84, v85
    s_waitcnt lgkmcnt(11)
    v_mfma_f32_16x16x32_bf16 v[64:67], v[32:35], v[128:131], v[64:67]
    ds_read_b64_tr_b16 v[58:59], v102 offset:22528
    v_cvt_pk_bf16_f32 v13, v86, v87
    v_mfma_f32_16x16x32_bf16 v[68:71], v[32:35], v[132:135], v[68:71]
    ds_read_b64_tr_b16 v[60:61], v103 offset:20480
    v_cvt_pk_bf16_f32 v14, v92, v93
    s_waitcnt lgkmcnt(11)
    v_mfma_f32_16x16x32_bf16 v[72:75], v[36:39], v[128:131], v[72:75]
    ds_read_b64_tr_b16 v[62:63], v103 offset:22528
    v_cvt_pk_bf16_f32 v15, v94, v95
    v_mfma_f32_16x16x32_bf16 v[76:79], v[36:39], v[132:135], v[76:79]
    ds_read_b64_tr_b16 v[16:17], v102 offset:24576
    s_waitcnt lgkmcnt(11)
    v_mfma_f32_16x16x32_bf16 v[64:67], v[40:43], v[136:139], v[64:67]
    ds_read_b64_tr_b16 v[18:19], v102 offset:26624
    s_cmp_eq_u32 s62, 0
    s_cbranch_scc1 M2_ST0
M2_SR0:
    v_mfma_f32_16x16x32_bf16 v[68:71], v[40:43], v[140:143], v[68:71]
    ds_read_b64_tr_b16 v[20:21], v103 offset:24576
    s_waitcnt lgkmcnt(11)
    v_mfma_f32_16x16x32_bf16 v[72:75], v[44:47], v[136:139], v[72:75]
    ds_read_b64_tr_b16 v[22:23], v103 offset:26624
    v_mfma_f32_16x16x32_bf16 v[76:79], v[44:47], v[140:143], v[76:79]
    ds_read_b64_tr_b16 v[24:25], v102 offset:28672
    s_waitcnt lgkmcnt(11)
    v_mfma_f32_16x16x32_bf16 v[64:67], v[48:51], v[144:147], v[64:67]
    ds_read_b64_tr_b16 v[26:27], v102 offset:30720
    v_mfma_f32_16x16x32_bf16 v[68:71], v[48:51], v[148:151], v[68:71]
    ds_read_b64_tr_b16 v[28:29], v103 offset:28672
    ds_read_b32 v110, v109
    s_waitcnt lgkmcnt(12)
    v_mfma_f32_16x16x32_bf16 v[72:75], v[52:55], v[144:147], v[72:75]
    ds_read_b64_tr_b16 v[30:31], v103 offset:30720
    v_mfma_f32_16x16x32_bf16 v[76:79], v[52:55], v[148:151], v[76:79]
    ds_read_b64_tr_b16 v[32:33], v102 offset:32768
    s_waitcnt lgkmcnt(12)
    v_mfma_f32_16x16x32_bf16 v[64:67], v[56:59], v[152:155], v[64:67]
    ds_read_b64_tr_b16 v[34:35], v102 offset:34816
    v_mfma_f32_16x16x32_bf16 v[68:71], v[56:59], v[156:159], v[68:71]
    ds_read_b64_tr_b16 v[36:37], v103 offset:32768
    v_add_u32 v107, 1, v107
    s_waitcnt lgkmcnt(12)
    v_mfma_f32_16x16x32_bf16 v[72:75], v[60:63], v[152:155], v[72:75]
    ds_read_b64_tr_b16 v[38:39], v103 offset:34816
    ds_write_b32 v108, v107
    v_mfma_f32_16x16x32_bf16 v[76:79], v[60:63], v[156:159], v[76:79]
    s_waitcnt lgkmcnt(6)
    v_cmp_gt_u32 vcc, s66, v110
    s_cbranch_vccnz SP13
SP13R:
    ds_read_b64_tr_b16 v[40:41], v104 offset:0
    v_mfma_f32_16x16x32_bf16 v[64:67], v[16:19], v[160:163], v[64:67]
    ds_read_b64_tr_b16 v[42:43], v104 offset:2048
    v_mfma_f32_16x16x32_bf16 v[68:71], v[16:19], v[164:167], v[68:71]
    ds_read_b64_tr_b16 v[44:45], v105 offset:0
    v_add_u32 v102, s64, v102
    v_mfma_f32_16x16x32_bf16 v[72:75], v[20:23], v[160:163], v[72:75]
    ds_read_b64_tr_b16 v[46:47], v105 offset:2048
    v_add_u32 v103, s64, v103
    v_mfma_f32_16x16x32_bf16 v[76:79], v[20:23], v[164:167], v[76:79]
    ds_read_b64_tr_b16 v[48:49], v104 offset:4096
    s_add_u32 s66, s66, 1
    v_mfma_f32_16x16x32_bf16 v[64:67], v[24:27], v[168:171], v[64:67]
    ds_read_b64_tr_b16 v[50:51], v104 offset:6144
    s_add_u32 s61, s65, s15
    v_mfma_f32_16x16x32_bf16 v[68:71], v[24:27], v[172:175], v[68:71]
    ds_read_b64_tr_b16 v[52:53], v105 offset:4096
    s_and_b32 s61, s61, 7
    s_waitcnt lgkmcnt(12)
    v_mfma_f32_16x16x32_bf16 v[72:75], v[28:31], v[168:171], v[72:75]
    ds_read_b64_tr_b16 v[54:55], v105 offset:6144
    s_cmp_eq_u32 s65, 0
    v_mfma_f32_16x16x32_bf16 v[76:79], v[28:31], v[172:175], v[76:79]
    ds_read_b64_tr_b16 v[56:57], v104 offset:8192
    s_cselect_b32 s61, 8, s61
    s_waitcnt lgkmcnt(12)
    v_mfma_f32_16x16x32_bf16 v[64:67], v[32:35], v[176:179], v[64:67]
    ds_read_b64_tr_b16 v[58:59], v104 offset:10240
    s_lshl_b32 s61, s61, 13
    v_mfma_f32_16x16x32_bf16 v[68:71], v[32:35], v[180:183], v[68:71]
    ds_read_b64_tr_b16 v[60:61], v105 offset:8192
    s_waitcnt lgkmcnt(12)
    v_mfma_f32_16x16x32_bf16 v[72:75], v[36:39], v[176:179], v[72:75]
    ds_read_b64_tr_b16 v[62:63], v105 offset:10240
    v_mfma_f32_16x16x32_bf16 v[76:79], v[36:39], v[180:183], v[76:79]
    ds_read_b64_tr_b16 v[16:17], v104 offset:12288
    s_waitcnt lgkmcnt(11)
    v_mfma_f32_16x16x32_bf16 v[80:83], v[40:43], v[184:187], v[64:67]
    ds_read_b64_tr_b16 v[18:19], v104 offset:14336
    v_mfma_f32_16x16x32_bf16 v[84:87], v[40:43], v[188:191], v[68:71]
    ds_read_b64_tr_b16 v[20:21], v105 offset:12288
    s_waitcnt lgkmcnt(11)
    v_mfma_f32_16x16x32_bf16 v[88:91], v[44:47], v[184:187], v[72:75]
    ds_read_b64_tr_b16 v[22:23], v105 offset:14336
    v_mfma_f32_16x16x32_bf16 v[92:95], v[44:47], v[188:191], v[76:79]
    ds_read_b64_tr_b16 v[24:25], v104 offset:16384
    s_waitcnt lgkmcnt(11)
    v_mfma_f32_16x16x32_bf16 v[80:83], v[48:51], v[192:195], v[80:83]
    ds_read_b64_tr_b16 v[26:27], v104 offset:18432
    v_mfma_f32_16x16x32_bf16 v[84:87], v[48:51], v[196:199], v[84:87]
    ds_read_b64_tr_b16 v[28:29], v105 offset:16384
    s_waitcnt lgkmcnt(11)
    v_mfma_f32_16x16x32_bf16 v[88:91], v[52:55], v[192:195], v[88:91]
    ds_read_b64_tr_b16 v[30:31], v105 offset:18432
    v_mfma_f32_16x16x32_bf16 v[92:95], v[52:55], v[196:199], v[92:95]
    ds_read_b64_tr_b16 v[32:33], v104 offset:20480
    s_waitcnt lgkmcnt(11)
    v_mfma_f32_16x16x32_bf16 v[80:83], v[56:59], v[200:203], v[80:83]
    ds_read_b64_tr_b16 v[34:35], v104 offset:22528
    v_mfma_f32_16x16x32_bf16 v[84:87], v[56:59], v[204:207], v[84:87]
    ds_read_b64_tr_b16 v[36:37], v105 offset:20480
    s_waitcnt lgkmcnt(11)
    v_mfma_f32_16x16x32_bf16 v[88:91], v[60:63], v[200:203], v[88:91]
    ds_read_b64_tr_b16 v[38:39], v105 offset:22528
    v_mfma_f32_16x16x32_bf16 v[92:95], v[60:63], v[204:207], v[92:95]
    ds_read_b64_tr_b16 v[40:41], v104 offset:24576
    s_waitcnt lgkmcnt(11)
    v_mfma_f32_16x16x32_bf16 v[80:83], v[16:19], v[208:211], v[80:83]
    ds_read_b64_tr_b16 v[42:43], v104 offset:26624
    v_mfma_f32_16x16x32_bf16 v[84:87], v[16:19], v[212:215], v[84:87]
    ds_read_b64_tr_b16 v[44:45], v105 offset:24576
    s_add_u32 s67, s60, s61
    s_waitcnt lgkmcnt(11)
    v_mfma_f32_16x16x32_bf16 v[88:91], v[20:23], v[208:211], v[88:91]
    ds_read_b64_tr_b16 v[46:47], v105 offset:26624
    v_mov_b32 v6, s65
    v_mfma_f32_16x16x32_bf16 v[92:95], v[20:23], v[212:215], v[92:95]
    ds_read_b64_tr_b16 v[48:49], v104 offset:28672
    s_add_u32 s65, s65, 1
    s_waitcnt lgkmcnt(11)
    v_mfma_f32_16x16x32_bf16 v[80:83], v[24:27], v[216:219], v[80:83]
    ds_read_b64_tr_b16 v[50:51], v104 offset:30720
    v_mfma_f32_16x16x32_bf16 v[84:87], v[24:27], v[220:223], v[84:87]
    ds_read_b64_tr_b16 v[52:53], v105 offset:28672
    ds_read_b32 v110, v109
    s_mov_b32 s62, 0
    s_nop 0
    s_waitcnt lgkmcnt(12)
    v_mfma_f32_16x16x32_bf16 v[88:91], v[28:31], v[216:219], v[88:91]
    ds_read_b64_tr_b16 v[54:55], v105 offset:30720
    v_mfma_f32_16x16x32_bf16 v[92:95], v[28:31], v[220:223], v[92:95]
    ds_read_b64_tr_b16 v[56:57], v104 offset:32768
    s_bitcmp1_b32 s63, s65
    s_cbranch_scc1 M2_FL
M2_FR:
    s_waitcnt lgkmcnt(12)
    v_mfma_f32_16x16x32_bf16 v[80:83], v[32:35], v[224:227], v[80:83]
    ds_read_b64_tr_b16 v[58:59], v104 offset:34816
    s_cmp_lt_u32 s65, 9
    v_mfma_f32_16x16x32_bf16 v[84:87], v[32:35], v[228:231], v[84:87]
    ds_read_b64_tr_b16 v[60:61], v105 offset:32768
    v_add_u32 v107, 1, v107
    s_waitcnt lgkmcnt(12)
    v_mfma_f32_16x16x32_bf16 v[88:91], v[36:39], v[224:227], v[88:91]
    ds_read_b64_tr_b16 v[62:63], v105 offset:34816
    ds_write_b32 v108, v107
    v_mfma_f32_16x16x32_bf16 v[92:95], v[36:39], v[228:231], v[92:95]
    s_cbranch_scc1 M2_L
    s_lshl_b32 s61, s5, 11
    s_add_u32 s61, s61, 147456
    v_add_u32 v7, s61, v106
    s_waitcnt lgkmcnt(0)
    v_mfma_f32_16x16x32_bf16 v[80:83], v[40:43], v[232:235], v[80:83]
    v_mfma_f32_16x16x32_bf16 v[84:87], v[40:43], v[236:239], v[84:87]
    v_mfma_f32_16x16x32_bf16 v[88:91], v[44:47], v[232:235], v[88:91]
    v_mfma_f32_16x16x32_bf16 v[92:95], v[44:47], v[236:239], v[92:95]
    v_mfma_f32_16x16x32_bf16 v[80:83], v[48:51], v[240:243], v[80:83]
    v_mfma_f32_16x16x32_bf16 v[84:87], v[48:51], v[244:247], v[84:87]
    v_mfma_f32_16x16x32_bf16 v[88:91], v[52:55], v[240:243], v[88:91]
    v_mfma_f32_16x16x32_bf16 v[92:95], v[52:55], v[244:247], v[92:95]
    v_mfma_f32_16x16x32_bf16 v[80:83], v[56:59], v[248:251], v[80:83]
    v_mfma_f32_16x16x32_bf16 v[84:87], v[56:59], v[252:255], v[84:87]
    v_mfma_f32_16x16x32_bf16 v[88:91], v[60:63], v[248:251], v[88:91]
    v_mfma_f32_16x16x32_bf16 v[92:95], v[60:63], v[252:255], v[92:95]
    s_nop 7
    v_cvt_pk_bf16_f32 v8, v80, v81
    v_cvt_pk_bf16_f32 v9, v82, v83
    v_cvt_pk_bf16_f32 v10, v88, v89
    v_cvt_pk_bf16_f32 v11, v90, v91
    ds_write_b128 v7, v[8:11] offset:0
    v_cvt_pk_bf16_f32 v12, v84, v85
    v_cvt_pk_bf16_f32 v13, v86, v87
    v_cvt_pk_bf16_f32 v14, v92, v93
    v_cvt_pk_bf16_f32 v15, v94, v95
    ds_write_b128 v7, v[12:15] offset:1024
    v_add_u32 v107, 1, v107
    ds_write_b32 v108, v107
    s_waitcnt lgkmcnt(0)
    s_endpgm
M2_FL:
    s_waitcnt vmcnt(0)
    s_mov_b64 exec, 1
    buffer_store_dword v6, v5, s[32:35], s19 offen sc1
    s_mov_b64 exec, -1
    s_branch M2_FR
M2_ST0:
    buffer_store_dwordx4 v[8:11], v106, s[32:35], s67 offen offset:0 sc1
    buffer_store_dwordx4 v[12:15], v106, s[32:35], s67 offen offset:1024 sc1
    s_branch M2_SR0
SP12:
    ds_read_b32 v110, v109
    s_add_u32 s99, s99, 1
    s_cmp_gt_u32 s99, 0x100000
    s_cbranch_scc1 K_END
    s_waitcnt lgkmcnt(0)
    v_cmp_gt_u32 vcc, s66, v110
    s_cbranch_vccnz SP12
    s_branch SP12R
SP13:
    ds_read_b32 v110, v109
    s_add_u32 s99, s99, 1
    s_cmp_gt_u32 s99, 0x100000
    s_cbranch_scc1 K_END
    s_waitcnt lgkmcnt(0)
    v_cmp_gt_u32 vcc, s66, v110
    s_cbranch_vccnz SP13
    s_branch SP13R
AX_D:
    s_barrier
    s_setprio 0
    s_nop 3
    s_mov_b32 s16, 311296
    v_lshlrev_b32 v12, 3, v8
    v_mad_u32_u24 v12, s16, v9, v12
    s_mul_i32 s16, s4, 2432
    s_add_u32 s16, s16, 20971520
    s_lshl_b32 s17, s3, 5
    s_add_u32 s17, s17, s16
    s_add_u32 s17, s17, 2048
    s_lshl_b32 s48, s3, 8
    s_add_u32 s16, s16, s48
    s_lshl_b32 s48, s7, 7
    s_add_u32 s16, s16, s48
    v_mov_b32 v255, v63
    v_add_u32 v14, 159872, v25
    v_cvt_pk_bf16_f32 v136, v96, v97
    v_cvt_pk_bf16_f32 v137, v98, v99
    v_cvt_pk_bf16_f32 v138, v100, v101
    v_cvt_pk_bf16_f32 v139, v102, v103
    s_lshl_b32 s66, s7, 7
    s_add_u32 s66, s66, 158208
    v_lshlrev_b32 v13, 4, v9
    v_add_u32 v13, s66, v13
    s_mov_b32 exec_lo, 0x00200020
    s_mov_b32 exec_hi, 0x00200020
    ds_write_b128 v13, v[96:99] offset:0
    ds_write_b128 v13, v[100:103] offset:64
    s_mov_b64 exec, -1
    s_cmp_eq_u32 s7, 1
    s_cbranch_scc0 AX_A0
    ds_write_b128 v14, v[136:139]
AX_A0:
    v_cvt_pk_bf16_f32 v16, v64, v65
    v_cvt_pk_bf16_f32 v17, v66, v67
    v_cvt_pk_bf16_f32 v18, v68, v69
    v_cvt_pk_bf16_f32 v19, v70, v71
    v_cvt_pk_bf16_f32 v20, v72, v73
    v_cvt_pk_bf16_f32 v21, v74, v75
    v_cvt_pk_bf16_f32 v22, v76, v77
    v_cvt_pk_bf16_f32 v23, v78, v79
    v_cvt_pk_bf16_f32 v24, v80, v81
    v_cvt_pk_bf16_f32 v25, v82, v83
    v_cvt_pk_bf16_f32 v26, v84, v85
    v_cvt_pk_bf16_f32 v27, v86, v87
    v_cvt_pk_bf16_f32 v28, v88, v89
    v_cvt_pk_bf16_f32 v29, v90, v91
    v_cvt_pk_bf16_f32 v30, v92, v93
    v_cvt_pk_bf16_f32 v31, v94, v95
    s_nop 1
    v_mfma_f32_16x16x32_bf16 v[32:35], v[112:115], v[16:19], 0
    v_mfma_f32_16x16x32_bf16 v[36:39], v[112:115], v[24:27], 0
    v_mfma_f32_16x16x32_bf16 v[32:35], v[120:123], v[24:27], v[32:35]
    v_mfma_f32_16x16x32_bf16 v[36:39], v[128:131], v[16:19], v[36:39]
    v_mfma_f32_16x16x32_bf16 v[40:43], v[116:119], v[16:19], 0
    v_mfma_f32_16x16x32_bf16 v[44:47], v[116:119], v[24:27], 0
    v_mfma_f32_16x16x32_bf16 v[40:43], v[124:127], v[24:27], v[40:43]
    v_mfma_f32_16x16x32_bf16 v[44:47], v[132:135], v[16:19], v[44:47]
    v_mfma_f32_16x16x32_bf16 v[48:51], v[112:115], v[20:23], 0
    v_mfma_f32_16x16x32_bf16 v[52:55], v[112:115], v[28:31], 0
    v_mfma_f32_16x16x32_bf16 v[48:51], v[120:123], v[28:31], v[48:51]
    v_mfma_f32_16x16x32_bf16 v[52:55], v[128:131], v[20:23], v[52:55]
    v_mfma_f32_16x16x32_bf16 v[56:59], v[116:119], v[20:23], 0
    v_mfma_f32_16x16x32_bf16 v[60:63], v[116:119], v[28:31], 0
    v_mfma_f32_16x16x32_bf16 v[56:59], v[124:127], v[28:31], v[56:59]
    v_mfma_f32_16x16x32_bf16 v[60:63], v[132:135], v[20:23], v[60:63]
    s_nop 7
    v_cvt_pk_bf16_f32 v236, v32, v36
    v_cvt_pk_bf16_f32 v237, v48, v52
    s_add_u32 s48, s16, 0
    buffer_store_dwordx2 v[236:237], v12, s[32:35], s48 offen sc1
    v_cvt_pk_bf16_f32 v238, v33, v37
    v_cvt_pk_bf16_f32 v239, v49, v53
    s_add_u32 s48, s16, 77824
    buffer_store_dwordx2 v[238:239], v12, s[32:35], s48 offen sc1
    v_cvt_pk_bf16_f32 v240, v34, v38
    v_cvt_pk_bf16_f32 v241, v50, v54
    s_add_u32 s48, s16, 155648
    buffer_store_dwordx2 v[240:241], v12, s[32:35], s48 offen sc1
    v_cvt_pk_bf16_f32 v242, v35, v39
    v_cvt_pk_bf16_f32 v243, v51, v55
    s_add_u32 s48, s16, 233472
    buffer_store_dwordx2 v[242:243], v12, s[32:35], s48 offen sc1
    v_cvt_pk_bf16_f32 v244, v40, v44
    v_cvt_pk_bf16_f32 v245, v56, v60
    s_add_u32 s48, s16, 1245184
    buffer_store_dwordx2 v[244:245], v12, s[32:35], s48 offen sc1
    v_cvt_pk_bf16_f32 v246, v41, v45
    v_cvt_pk_bf16_f32 v247, v57, v61
    s_add_u32 s48, s16, 1323008
    buffer_store_dwordx2 v[246:247], v12, s[32:35], s48 offen sc1
    v_cvt_pk_bf16_f32 v248, v42, v46
    v_cvt_pk_bf16_f32 v249, v58, v62
    s_add_u32 s48, s16, 1400832
    buffer_store_dwordx2 v[248:249], v12, s[32:35], s48 offen sc1
    v_cvt_pk_bf16_f32 v250, v43, v47
    v_cvt_pk_bf16_f32 v251, v59, v63
    s_add_u32 s48, s16, 1478656
    buffer_store_dwordx2 v[250:251], v12, s[32:35], s48 offen sc1
    s_mov_b32 s47, 0
AX_V0:
    v_cmp_eq_u32 vcc, 0, v254
    s_cbranch_vccz AX_V1
    s_add_u32 s47, s47, 1
    s_cmp_gt_u32 s47, 32768
    s_cbranch_scc1 AX_V1
    s_sleep 8
    buffer_load_dword v254, v255, s[40:43], 0 offen sc1
    s_waitcnt vmcnt(0)
    s_branch AX_V0
AX_V1:
    s_waitcnt lgkmcnt(0)
    s_barrier
    s_barrier
    s_cmp_eq_u32 s7, 0
    s_cbranch_scc0 AX_A2
    ds_read_b128 v[140:143], v14
    s_waitcnt lgkmcnt(0)
    v_mov_b32_dpp v144, v136 row_ror:8 row_mask:0xf bank_mask:0xf
    v_mov_b32_dpp v145, v137 row_ror:8 row_mask:0xf bank_mask:0xf
    v_mov_b32_dpp v146, v138 row_ror:8 row_mask:0xf bank_mask:0xf
    v_mov_b32_dpp v147, v139 row_ror:8 row_mask:0xf bank_mask:0xf
    v_mov_b32_dpp v148, v140 row_ror:8 row_mask:0xf bank_mask:0xf
    v_mov_b32_dpp v149, v141 row_ror:8 row_mask:0xf bank_mask:0xf
    v_mov_b32_dpp v150, v142 row_ror:8 row_mask:0xf bank_mask:0xf
    v_mov_b32_dpp v151, v143 row_ror:8 row_mask:0xf bank_mask:0xf
    s_nop 1
    v_mfma_f32_16x16x32_bf16 v[64:67], v[112:115], v[136:139], 0
    v_mfma_f32_16x16x32_bf16 v[68:71], v[112:115], v[144:147], 0
    v_mfma_f32_16x16x32_bf16 v[64:67], v[120:123], v[144:147], v[64:67]
    v_mfma_f32_16x16x32_bf16 v[68:71], v[128:131], v[136:139], v[68:71]
    v_mfma_f32_16x16x32_bf16 v[72:75], v[116:119], v[136:139], 0
    v_mfma_f32_16x16x32_bf16 v[76:79], v[116:119], v[144:147], 0
    v_mfma_f32_16x16x32_bf16 v[72:75], v[124:127], v[144:147], v[72:75]
    v_mfma_f32_16x16x32_bf16 v[76:79], v[132:135], v[136:139], v[76:79]
    v_mfma_f32_16x16x32_bf16 v[80:83], v[112:115], v[140:143], 0
    v_mfma_f32_16x16x32_bf16 v[84:87], v[112:115], v[148:151], 0
    v_mfma_f32_16x16x32_bf16 v[80:83], v[120:123], v[148:151], v[80:83]
    v_mfma_f32_16x16x32_bf16 v[84:87], v[128:131], v[140:143], v[84:87]
    v_mfma_f32_16x16x32_bf16 v[88:91], v[116:119], v[140:143], 0
    v_mfma_f32_16x16x32_bf16 v[92:95], v[116:119], v[148:151], 0
    v_mfma_f32_16x16x32_bf16 v[88:91], v[124:127], v[148:151], v[88:91]
    v_mfma_f32_16x16x32_bf16 v[92:95], v[132:135], v[140:143], v[92:95]
    s_nop 7
    s_mov_b32 s49, 0x000f000f
    s_cmp_eq_u32 s3, 7
    s_cselect_b32 s49, 0x001f001f, s49
    s_mov_b32 exec_lo, s49
    s_mov_b32 exec_hi, s49
    v_cvt_pk_bf16_f32 v96, v64, v68
    v_cvt_pk_bf16_f32 v97, v80, v84
    s_add_u32 s48, s17, 0
    buffer_store_dwordx2 v[96:97], v12, s[32:35], s48 offen sc1
    v_cvt_pk_bf16_f32 v98, v65, v69
    v_cvt_pk_bf16_f32 v99, v81, v85
    s_add_u32 s48, s17, 77824
    buffer_store_dwordx2 v[98:99], v12, s[32:35], s48 offen sc1
    v_cvt_pk_bf16_f32 v100, v66, v70
    v_cvt_pk_bf16_f32 v101, v82, v86
    s_add_u32 s48, s17, 155648
    buffer_store_dwordx2 v[100:101], v12, s[32:35], s48 offen sc1
    v_cvt_pk_bf16_f32 v102, v67, v71
    v_cvt_pk_bf16_f32 v103, v83, v87
    s_add_u32 s48, s17, 233472
    buffer_store_dwordx2 v[102:103], v12, s[32:35], s48 offen sc1
    v_cvt_pk_bf16_f32 v104, v72, v76
    v_cvt_pk_bf16_f32 v105, v88, v92
    s_add_u32 s48, s17, 1245184
    buffer_store_dwordx2 v[104:105], v12, s[32:35], s48 offen sc1
    v_cvt_pk_bf16_f32 v106, v73, v77
    v_cvt_pk_bf16_f32 v107, v89, v93
    s_add_u32 s48, s17, 1323008
    buffer_store_dwordx2 v[106:107], v12, s[32:35], s48 offen sc1
    v_cvt_pk_bf16_f32 v108, v74, v78
    v_cvt_pk_bf16_f32 v109, v90, v94
    s_add_u32 s48, s17, 1400832
    buffer_store_dwordx2 v[108:109], v12, s[32:35], s48 offen sc1
    v_cvt_pk_bf16_f32 v110, v75, v79
    v_cvt_pk_bf16_f32 v111, v91, v95
    s_add_u32 s48, s17, 1478656
    buffer_store_dwordx2 v[110:111], v12, s[32:35], s48 offen sc1
    s_mov_b64 exec, -1
AX_A2:
    s_lshr_b32 s48, s3, 2
    s_lshl_b32 s48, s48, 1
    s_and_b32 s49, s3, 1
    s_add_u32 s48, s48, s49
    s_add_u32 s48, s48, 0
    s_and_b32 s48, s48, 3
    v_lshlrev_b32 v228, 4, v0
    v_cvt_f32_u32 v11, v9
    s_lshl_b32 s49, s48, 6
    s_add_u32 s49, s49, 158208
    v_lshlrev_b32 v13, 2, v8
    v_add_u32 v224, s49, v13
    s_lshr_b32 s49, s48, 1
    s_and_b32 s50, s48, 1
    s_lshl_b32 s51, s49, 12
    s_lshl_b32 s52, s50, 10
    s_add_u32 s51, s51, s52
    v_add_u32 v220, s51, v228
    s_lshl_b32 s49, s49, 5
    s_add_u32 s49, s49, s52
    s_add_u32 s49, s49, s4
    v_lshlrev_b32 v5, 6, v8
    v_add_u32 v6, s49, v5
    v_cvt_f32_u32 v5, v6
    v_mul_f32 v5, 0x3a000000, v5
    v_mul_f32 v13, v5, v11
    s_movk_i32 s49, 1152
    v_lshlrev_b32 v4, 4, v9
    v_mad_u32_u24 v216, v6, s49, v4
    v_fmamk_f32 v30, v5, 0x00000000, v13
    v_fmamk_f32 v31, v5, 0x42000000, v13
    v_cos_f32 v32, v30
    v_sin_f32 v33, v30
    v_cos_f32 v34, v31
    v_sin_f32 v35, v31
    v_cvt_pk_bf16_f32 v136, v32, v33
    v_cvt_pk_bf16_f32 v137, v34, v35
    v_fmamk_f32 v30, v5, 0x40800000, v13
    v_fmamk_f32 v31, v5, 0x42100000, v13
    v_cos_f32 v32, v30
    v_sin_f32 v33, v30
    v_cos_f32 v34, v31
    v_sin_f32 v35, v31
    v_cvt_pk_bf16_f32 v138, v32, v33
    v_cvt_pk_bf16_f32 v139, v34, v35
    v_fmamk_f32 v30, v5, 0x41000000, v13
    v_fmamk_f32 v31, v5, 0x42200000, v13
    v_cos_f32 v32, v30
    v_sin_f32 v33, v30
    v_cos_f32 v34, v31
    v_sin_f32 v35, v31
    v_cvt_pk_bf16_f32 v140, v32, v33
    v_cvt_pk_bf16_f32 v141, v34, v35
    v_fmamk_f32 v30, v5, 0x41400000, v13
    v_fmamk_f32 v31, v5, 0x42300000, v13
    v_cos_f32 v32, v30
    v_sin_f32 v33, v30
    v_cos_f32 v34, v31
    v_sin_f32 v35, v31
    v_cvt_pk_bf16_f32 v142, v32, v33
    v_cvt_pk_bf16_f32 v143, v34, v35
    v_fmamk_f32 v30, v5, 0x41800000, v13
    v_fmamk_f32 v31, v5, 0x42400000, v13
    v_cos_f32 v32, v30
    v_sin_f32 v33, v30
    v_cos_f32 v34, v31
    v_sin_f32 v35, v31
    v_cvt_pk_bf16_f32 v144, v32, v33
    v_cvt_pk_bf16_f32 v145, v34, v35
    v_fmamk_f32 v30, v5, 0x41a00000, v13
    v_fmamk_f32 v31, v5, 0x42500000, v13
    v_cos_f32 v32, v30
    v_sin_f32 v33, v30
    v_cos_f32 v34, v31
    v_sin_f32 v35, v31
    v_cvt_pk_bf16_f32 v146, v32, v33
    v_cvt_pk_bf16_f32 v147, v34, v35
    v_fmamk_f32 v30, v5, 0x41c00000, v13
    v_fmamk_f32 v31, v5, 0x42600000, v13
    v_cos_f32 v32, v30
    v_sin_f32 v33, v30
    v_cos_f32 v34, v31
    v_sin_f32 v35, v31
    v_cvt_pk_bf16_f32 v148, v32, v33
    v_cvt_pk_bf16_f32 v149, v34, v35
    v_fmamk_f32 v30, v5, 0x41e00000, v13
    v_fmamk_f32 v31, v5, 0x42700000, v13
    v_cos_f32 v32, v30
    v_sin_f32 v33, v30
    v_cos_f32 v34, v31
    v_sin_f32 v35, v31
    v_cvt_pk_bf16_f32 v150, v32, v33
    v_cvt_pk_bf16_f32 v151, v34, v35
    s_waitcnt vmcnt(0)
    v_mov_b32 v10, 1
    s_mov_b64 exec, 1
    buffer_store_dword v10, v231, s[32:35], s71 offen sc1
    s_mov_b64 exec, -1
    s_lshr_b32 s48, s3, 2
    s_lshl_b32 s48, s48, 1
    s_and_b32 s49, s3, 1
    s_add_u32 s48, s48, s49
    s_add_u32 s48, s48, 1
    s_and_b32 s48, s48, 3
    v_lshlrev_b32 v228, 4, v0
    v_cvt_f32_u32 v11, v9
    s_lshl_b32 s49, s48, 6
    s_add_u32 s49, s49, 158208
    v_lshlrev_b32 v13, 2, v8
    v_add_u32 v225, s49, v13
    s_lshr_b32 s49, s48, 1
    s_and_b32 s50, s48, 1
    s_lshl_b32 s51, s49, 12
    s_lshl_b32 s52, s50, 10
    s_add_u32 s51, s51, s52
    v_add_u32 v221, s51, v228
    s_lshl_b32 s49, s49, 5
    s_add_u32 s49, s49, s52
    s_add_u32 s49, s49, s4
    v_lshlrev_b32 v5, 6, v8
    v_add_u32 v6, s49, v5
    v_cvt_f32_u32 v5, v6
    v_mul_f32 v5, 0x3a000000, v5
    v_mul_f32 v13, v5, v11
    s_movk_i32 s49, 1152
    v_lshlrev_b32 v4, 4, v9
    v_mad_u32_u24 v217, v6, s49, v4
    v_fmamk_f32 v30, v5, 0x00000000, v13
    v_fmamk_f32 v31, v5, 0x42000000, v13
    v_cos_f32 v32, v30
    v_sin_f32 v33, v30
    v_cos_f32 v34, v31
    v_sin_f32 v35, v31
    v_cvt_pk_bf16_f32 v152, v32, v33
    v_cvt_pk_bf16_f32 v153, v34, v35
    v_fmamk_f32 v30, v5, 0x40800000, v13
    v_fmamk_f32 v31, v5, 0x42100000, v13
    v_cos_f32 v32, v30
    v_sin_f32 v33, v30
    v_cos_f32 v34, v31
    v_sin_f32 v35, v31
    v_cvt_pk_bf16_f32 v154, v32, v33
    v_cvt_pk_bf16_f32 v155, v34, v35
    v_fmamk_f32 v30, v5, 0x41000000, v13
    v_fmamk_f32 v31, v5, 0x42200000, v13
    v_cos_f32 v32, v30
    v_sin_f32 v33, v30
    v_cos_f32 v34, v31
    v_sin_f32 v35, v31
    v_cvt_pk_bf16_f32 v156, v32, v33
    v_cvt_pk_bf16_f32 v157, v34, v35
    v_fmamk_f32 v30, v5, 0x41400000, v13
    v_fmamk_f32 v31, v5, 0x42300000, v13
    v_cos_f32 v32, v30
    v_sin_f32 v33, v30
    v_cos_f32 v34, v31
    v_sin_f32 v35, v31
    v_cvt_pk_bf16_f32 v158, v32, v33
    v_cvt_pk_bf16_f32 v159, v34, v35
    v_fmamk_f32 v30, v5, 0x41800000, v13
    v_fmamk_f32 v31, v5, 0x42400000, v13
    v_cos_f32 v32, v30
    v_sin_f32 v33, v30
    v_cos_f32 v34, v31
    v_sin_f32 v35, v31
    v_cvt_pk_bf16_f32 v160, v32, v33
    v_cvt_pk_bf16_f32 v161, v34, v35
    v_fmamk_f32 v30, v5, 0x41a00000, v13
    v_fmamk_f32 v31, v5, 0x42500000, v13
    v_cos_f32 v32, v30
    v_sin_f32 v33, v30
    v_cos_f32 v34, v31
    v_sin_f32 v35, v31
    v_cvt_pk_bf16_f32 v162, v32, v33
    v_cvt_pk_bf16_f32 v163, v34, v35
    v_fmamk_f32 v30, v5, 0x41c00000, v13
    v_fmamk_f32 v31, v5, 0x42600000, v13
    v_cos_f32 v32, v30
    v_sin_f32 v33, v30
    v_cos_f32 v34, v31
    v_sin_f32 v35, v31
    v_cvt_pk_bf16_f32 v164, v32, v33
    v_cvt_pk_bf16_f32 v165, v34, v35
    v_fmamk_f32 v30, v5, 0x41e00000, v13
    v_fmamk_f32 v31, v5, 0x42700000, v13
    v_cos_f32 v32, v30
    v_sin_f32 v33, v30
    v_cos_f32 v34, v31
    v_sin_f32 v35, v31
    v_cvt_pk_bf16_f32 v166, v32, v33
    v_cvt_pk_bf16_f32 v167, v34, v35
    s_lshr_b32 s48, s3, 2
    s_lshl_b32 s48, s48, 1
    s_and_b32 s49, s3, 1
    s_add_u32 s48, s48, s49
    s_add_u32 s48, s48, 2
    s_and_b32 s48, s48, 3
    v_lshlrev_b32 v228, 4, v0
    v_cvt_f32_u32 v11, v9
    s_lshl_b32 s49, s48, 6
    s_add_u32 s49, s49, 158208
    v_lshlrev_b32 v13, 2, v8
    v_add_u32 v226, s49, v13
    s_lshr_b32 s49, s48, 1
    s_and_b32 s50, s48, 1
    s_lshl_b32 s51, s49, 12
    s_lshl_b32 s52, s50, 10
    s_add_u32 s51, s51, s52
    v_add_u32 v222, s51, v228
    s_lshl_b32 s49, s49, 5
    s_add_u32 s49, s49, s52
    s_add_u32 s49, s49, s4
    v_lshlrev_b32 v5, 6, v8
    v_add_u32 v6, s49, v5
    v_cvt_f32_u32 v5, v6
    v_mul_f32 v5, 0x3a000000, v5
    v_mul_f32 v13, v5, v11
    s_movk_i32 s49, 1152
    v_lshlrev_b32 v4, 4, v9
    v_mad_u32_u24 v218, v6, s49, v4
    v_fmamk_f32 v30, v5, 0x00000000, v13
    v_fmamk_f32 v31, v5, 0x42000000, v13
    v_cos_f32 v32, v30
    v_sin_f32 v33, v30
    v_cos_f32 v34, v31
    v_sin_f32 v35, v31
    v_cvt_pk_bf16_f32 v168, v32, v33
    v_cvt_pk_bf16_f32 v169, v34, v35
    v_fmamk_f32 v30, v5, 0x40800000, v13
    v_fmamk_f32 v31, v5, 0x42100000, v13
    v_cos_f32 v32, v30
    v_sin_f32 v33, v30
    v_cos_f32 v34, v31
    v_sin_f32 v35, v31
    v_cvt_pk_bf16_f32 v170, v32, v33
    v_cvt_pk_bf16_f32 v171, v34, v35
    v_fmamk_f32 v30, v5, 0x41000000, v13
    v_fmamk_f32 v31, v5, 0x42200000, v13
    v_cos_f32 v32, v30
    v_sin_f32 v33, v30
    v_cos_f32 v34, v31
    v_sin_f32 v35, v31
    v_cvt_pk_bf16_f32 v172, v32, v33
    v_cvt_pk_bf16_f32 v173, v34, v35
    v_fmamk_f32 v30, v5, 0x41400000, v13
    v_fmamk_f32 v31, v5, 0x42300000, v13
    v_cos_f32 v32, v30
    v_sin_f32 v33, v30
    v_cos_f32 v34, v31
    v_sin_f32 v35, v31
    v_cvt_pk_bf16_f32 v174, v32, v33
    v_cvt_pk_bf16_f32 v175, v34, v35
    v_fmamk_f32 v30, v5, 0x41800000, v13
    v_fmamk_f32 v31, v5, 0x42400000, v13
    v_cos_f32 v32, v30
    v_sin_f32 v33, v30
    v_cos_f32 v34, v31
    v_sin_f32 v35, v31
    v_cvt_pk_bf16_f32 v176, v32, v33
    v_cvt_pk_bf16_f32 v177, v34, v35
    v_fmamk_f32 v30, v5, 0x41a00000, v13
    v_fmamk_f32 v31, v5, 0x42500000, v13
    v_cos_f32 v32, v30
    v_sin_f32 v33, v30
    v_cos_f32 v34, v31
    v_sin_f32 v35, v31
    v_cvt_pk_bf16_f32 v178, v32, v33
    v_cvt_pk_bf16_f32 v179, v34, v35
    v_fmamk_f32 v30, v5, 0x41c00000, v13
    v_fmamk_f32 v31, v5, 0x42600000, v13
    v_cos_f32 v32, v30
    v_sin_f32 v33, v30
    v_cos_f32 v34, v31
    v_sin_f32 v35, v31
    v_cvt_pk_bf16_f32 v180, v32, v33
    v_cvt_pk_bf16_f32 v181, v34, v35
    v_fmamk_f32 v30, v5, 0x41e00000, v13
    v_fmamk_f32 v31, v5, 0x42700000, v13
    v_cos_f32 v32, v30
    v_sin_f32 v33, v30
    v_cos_f32 v34, v31
    v_sin_f32 v35, v31
    v_cvt_pk_bf16_f32 v182, v32, v33
    v_cvt_pk_bf16_f32 v183, v34, v35
    s_lshr_b32 s48, s3, 2
    s_lshl_b32 s48, s48, 1
    s_and_b32 s49, s3, 1
    s_add_u32 s48, s48, s49
    s_add_u32 s48, s48, 3
    s_and_b32 s48, s48, 3
    v_lshlrev_b32 v228, 4, v0
    v_cvt_f32_u32 v11, v9
    s_lshl_b32 s49, s48, 6
    s_add_u32 s49, s49, 158208
    v_lshlrev_b32 v13, 2, v8
    v_add_u32 v227, s49, v13
    s_lshr_b32 s49, s48, 1
    s_and_b32 s50, s48, 1
    s_lshl_b32 s51, s49, 12
    s_lshl_b32 s52, s50, 10
    s_add_u32 s51, s51, s52
    v_add_u32 v223, s51, v228
    s_lshl_b32 s49, s49, 5
    s_add_u32 s49, s49, s52
    s_add_u32 s49, s49, s4
    v_lshlrev_b32 v5, 6, v8
    v_add_u32 v6, s49, v5
    v_cvt_f32_u32 v5, v6
    v_mul_f32 v5, 0x3a000000, v5
    v_mul_f32 v13, v5, v11
    s_movk_i32 s49, 1152
    v_lshlrev_b32 v4, 4, v9
    v_mad_u32_u24 v219, v6, s49, v4
    v_fmamk_f32 v30, v5, 0x00000000, v13
    v_fmamk_f32 v31, v5, 0x42000000, v13
    v_cos_f32 v32, v30
    v_sin_f32 v33, v30
    v_cos_f32 v34, v31
    v_sin_f32 v35, v31
    v_cvt_pk_bf16_f32 v184, v32, v33
    v_cvt_pk_bf16_f32 v185, v34, v35
    v_fmamk_f32 v30, v5, 0x40800000, v13
    v_fmamk_f32 v31, v5, 0x42100000, v13
    v_cos_f32 v32, v30
    v_sin_f32 v33, v30
    v_cos_f32 v34, v31
    v_sin_f32 v35, v31
    v_cvt_pk_bf16_f32 v186, v32, v33
    v_cvt_pk_bf16_f32 v187, v34, v35
    v_fmamk_f32 v30, v5, 0x41000000, v13
    v_fmamk_f32 v31, v5, 0x42200000, v13
    v_cos_f32 v32, v30
    v_sin_f32 v33, v30
    v_cos_f32 v34, v31
    v_sin_f32 v35, v31
    v_cvt_pk_bf16_f32 v188, v32, v33
    v_cvt_pk_bf16_f32 v189, v34, v35
    v_fmamk_f32 v30, v5, 0x41400000, v13
    v_fmamk_f32 v31, v5, 0x42300000, v13
    v_cos_f32 v32, v30
    v_sin_f32 v33, v30
    v_cos_f32 v34, v31
    v_sin_f32 v35, v31
    v_cvt_pk_bf16_f32 v190, v32, v33
    v_cvt_pk_bf16_f32 v191, v34, v35
    v_fmamk_f32 v30, v5, 0x41800000, v13
    v_fmamk_f32 v31, v5, 0x42400000, v13
    v_cos_f32 v32, v30
    v_sin_f32 v33, v30
    v_cos_f32 v34, v31
    v_sin_f32 v35, v31
    v_cvt_pk_bf16_f32 v192, v32, v33
    v_cvt_pk_bf16_f32 v193, v34, v35
    v_fmamk_f32 v30, v5, 0x41a00000, v13
    v_fmamk_f32 v31, v5, 0x42500000, v13
    v_cos_f32 v32, v30
    v_sin_f32 v33, v30
    v_cos_f32 v34, v31
    v_sin_f32 v35, v31
    v_cvt_pk_bf16_f32 v194, v32, v33
    v_cvt_pk_bf16_f32 v195, v34, v35
    v_fmamk_f32 v30, v5, 0x41c00000, v13
    v_fmamk_f32 v31, v5, 0x42600000, v13
    v_cos_f32 v32, v30
    v_sin_f32 v33, v30
    v_cos_f32 v34, v31
    v_sin_f32 v35, v31
    v_cvt_pk_bf16_f32 v196, v32, v33
    v_cvt_pk_bf16_f32 v197, v34, v35
    v_fmamk_f32 v30, v5, 0x41e00000, v13
    v_fmamk_f32 v31, v5, 0x42700000, v13
    v_cos_f32 v32, v30
    v_sin_f32 v33, v30
    v_cos_f32 v34, v31
    v_sin_f32 v35, v31
    v_cvt_pk_bf16_f32 v198, v32, v33
    v_cvt_pk_bf16_f32 v199, v34, v35
    v_bfe_u32 v4, v8, 1, 2
    v_cmp_eq_u32 vcc, v4, v9
    v_and_b32 v5, 1, v8
    v_lshrrev_b32 v7, 3, v8
    v_mov_b32 v6, 0x3f80
    v_lshl_add_u32 v5, v7, 1, v5
    v_cndmask_b32 v6, 0, v6, vcc
    v_cmp_eq_u32 vcc, 0, v5
    s_nop 1
    v_cndmask_b32 v200, 0, v6, vcc
    v_lshlrev_b32 v204, 16, v200
    v_cmp_eq_u32 vcc, 1, v5
    s_nop 1
    v_cndmask_b32 v201, 0, v6, vcc
    v_lshlrev_b32 v205, 16, v201
    v_cmp_eq_u32 vcc, 2, v5
    s_nop 1
    v_cndmask_b32 v202, 0, v6, vcc
    v_lshlrev_b32 v206, 16, v202
    v_cmp_eq_u32 vcc, 3, v5
    s_nop 1
    v_cndmask_b32 v203, 0, v6, vcc
    v_lshlrev_b32 v207, 16, v203
    v_and_b32 v4, 1, v0
    v_lshlrev_b32 v4, 3, v4
    s_lshl_b32 s49, s7, 2
    v_add_u32 v4, s49, v4
    v_bfe_u32 v5, v0, 1, 3
    v_lshl_add_u32 v229, v5, 7, v4
    v_sub_u32 v5, s3, v5
    v_and_b32 v5, 7, v5
    v_add_u32 v254, 1, v5
    v_and_b32 v4, 7, v0
    v_lshlrev_b32 v4, 7, v4
    s_lshr_b32 s49, s3, 1
    s_lshl_b32 s49, s49, 2
    v_add_u32 v230, s49, v4
    s_sub_u32 s48, 32, s4
    s_and_b32 s48, s48, 31
    s_movk_i32 s49, 2432
    v_mul_u32_u24 v12, s49, v9
    v_lshlrev_b32 v4, 4, v8
    s_lshl_b32 s54, s15, 6
    s_lshl_b32 s49, s7, 5
    s_add_u32 s54, s54, s49
    s_and_b32 s55, s3, 2
    s_lshl_b32 s55, s55, 4
    s_add_u32 s55, s55, 512
    s_mul_i32 s48, s48, 77824
    s_mul_i32 s50, s4, 77824
    v_add_u32 v5, v12, v4
    v_add_u32 v6, 256, v12
    v_sub_u32 v6, v6, v4
    s_sub_u32 s49, 543, s54
    s_lshl_b32 s49, s49, 3
    s_add_u32 s49, s49, s48
    s_lshl_b32 s51, s54, 3
    s_add_u32 s51, s51, s50
    s_cmp_ge_u32 s54, 288
    s_cselect_b32 s49, s49, s51
    s_cselect_b64 vcc, -1, 0
    v_cndmask_b32 v5, v5, v6, vcc
    v_add_u32 v208, s49, v5
    s_sub_u32 s49, 575, s55
    s_lshl_b32 s49, s49, 3
    s_add_u32 s49, s49, s48
    v_add_u32 v6, s49, v12
    v_sub_u32 v209, v6, v4
    ds_read_b32 v224, v224
    ds_read_b32 v225, v225
    ds_read_b32 v226, v226
    ds_read_b32 v227, v227
    s_lshl_b32 s65, s4, 10
    s_add_u32 s65, s65, 25165824
    s_waitcnt lgkmcnt(0)
    v_mul_f32 v224, 0xbfb8aa3b, v224
    v_exp_f32 v224, v224
    s_nop 0
    v_add_f32 v224, 1.0, v224
    v_rcp_f32 v224, v224
    v_mul_f32 v225, 0xbfb8aa3b, v225
    v_exp_f32 v225, v225
    s_nop 0
    v_add_f32 v225, 1.0, v225
    v_rcp_f32 v225, v225
    v_mul_f32 v226, 0xbfb8aa3b, v226
    v_exp_f32 v226, v226
    s_nop 0
    v_add_f32 v226, 1.0, v226
    v_rcp_f32 v226, v226
    v_mul_f32 v227, 0xbfb8aa3b, v227
    v_exp_f32 v227, v227
    s_nop 0
    v_add_f32 v227, 1.0, v227
    v_rcp_f32 v227, v227
    s_mov_b32 s47, 0
    s_lshl_b32 s16, s7, 8
    s_add_u32 s16, s16, 156672
    v_and_b32 v15, 1, v0
    v_mul_u32_u24 v15, 516, v15
    v_add_u32 v15, s16, v15
    s_and_b32 s16, s4, 0
    s_add_u32 s16, s16, 27
PC2:
    s_sleep 3
    ds_read_b32 v5, v15
    s_add_u32 s99, s99, 1
    s_cmp_gt_u32 s99, 0x100000
    s_cbranch_scc1 K_END
    s_waitcnt lgkmcnt(0)
    v_cmp_gt_u32 vcc, s16, v5
    s_cbranch_vccnz PC2
    s_setprio 0
    s_mov_b32 s16, 25231360
    s_branch GP3f
GP3:
    s_sleep 30
GP3f:
    buffer_load_dwordx4 v[96:99], v228, s[32:35], s16 offen sc1
    buffer_load_dwordx4 v[100:103], v228, s[32:35], s16 offen offset:1024 sc1
    s_add_u32 s47, s47, 1
    s_waitcnt vmcnt(0)
    v_min3_u32 v5, v96, v97, v98
    v_min3_u32 v5, v5, v99, v100
    v_min3_u32 v5, v5, v101, v102
    v_min_u32 v5, v5, v103
    v_cmp_eq_u32 vcc, 0, v5
    s_cmp_gt_u32 s47, 32768
    s_cbranch_scc1 GP3x
    s_cbranch_vccnz GP3
GP3x:
    s_mov_b32 s17, 20971520
    buffer_load_dwordx4 v[16:19], v208, s[32:35], s17 offen sc1
    s_mov_b32 s17, 20981248
    buffer_load_dwordx4 v[20:23], v208, s[32:35], s17 offen sc1
    s_mov_b32 s17, 20990976
    buffer_load_dwordx4 v[24:27], v208, s[32:35], s17 offen sc1
    s_mov_b32 s17, 21000704
    buffer_load_dwordx4 v[28:31], v208, s[32:35], s17 offen sc1
    s_mov_b32 s17, 21010432
    buffer_load_dwordx4 v[32:35], v208, s[32:35], s17 offen sc1
    s_mov_b32 s17, 21020160
    buffer_load_dwordx4 v[36:39], v208, s[32:35], s17 offen sc1
    s_mov_b32 s17, 21029888
    buffer_load_dwordx4 v[40:43], v208, s[32:35], s17 offen sc1
    s_mov_b32 s17, 21039616
    buffer_load_dwordx4 v[44:47], v208, s[32:35], s17 offen sc1
    s_cmp_eq_u32 s7, 1
    s_cbranch_scc0 AX_U
    s_mov_b32 s17, 20971520
    buffer_load_dwordx4 v[48:51], v209, s[32:35], s17 offen sc1
    s_mov_b32 s17, 20981248
    buffer_load_dwordx4 v[52:55], v209, s[32:35], s17 offen sc1
    s_mov_b32 s17, 20990976
    buffer_load_dwordx4 v[56:59], v209, s[32:35], s17 offen sc1
    s_mov_b32 s17, 21000704
    buffer_load_dwordx4 v[60:63], v209, s[32:35], s17 offen sc1
    s_mov_b32 s17, 21010432
    buffer_load_dwordx4 v[64:67], v209, s[32:35], s17 offen sc1
    s_mov_b32 s17, 21020160
    buffer_load_dwordx4 v[68:71], v209, s[32:35], s17 offen sc1
    s_mov_b32 s17, 21029888
    buffer_load_dwordx4 v[72:75], v209, s[32:35], s17 offen sc1
    s_mov_b32 s17, 21039616
    buffer_load_dwordx4 v[76:79], v209, s[32:35], s17 offen sc1
    s_branch GP4f
GP4:
    s_sleep 10
GP4f:
    buffer_load_dword v5, v230, s[32:35], s65 offen sc1
    s_add_u32 s47, s47, 1
    s_waitcnt vmcnt(0)
    v_cmp_gt_u32 vcc, 1, v5
    s_cmp_gt_u32 s47, 32768
    s_cbranch_scc1 GP4x
    s_cbranch_vccnz GP4
GP4x:
    s_mul_i32 s16, s4, 589824
    s_lshl_b32 s17, s3, 10
    s_add_u32 s16, s16, s17
    s_add_u32 s16, s16, 65536
    buffer_load_dwordx4 v[80:83], v228, s[32:35], s16 offen sc1
    s_add_u32 s16, s16, 73728
    buffer_load_dwordx4 v[84:87], v228, s[32:35], s16 offen sc1
    s_add_u32 s16, s16, 73728
    buffer_load_dwordx4 v[88:91], v228, s[32:35], s16 offen sc1
    s_add_u32 s16, s16, 73728
    buffer_load_dwordx4 v[92:95], v228, s[32:35], s16 offen sc1
    s_add_u32 s16, s16, 73728
    buffer_load_dwordx4 v[96:99], v228, s[32:35], s16 offen sc1
    s_add_u32 s16, s16, 73728
    buffer_load_dwordx4 v[100:103], v228, s[32:35], s16 offen sc1
    s_add_u32 s16, s16, 73728
    buffer_load_dwordx4 v[104:107], v228, s[32:35], s16 offen sc1
    s_add_u32 s16, s16, 73728
    buffer_load_dwordx4 v[108:111], v228, s[32:35], s16 offen sc1
    v_swap_b32 v50, v52
    v_swap_b32 v51, v53
    v_swap_b32 v58, v60
    v_swap_b32 v59, v61
    v_swap_b32 v66, v68
    v_swap_b32 v67, v69
    v_swap_b32 v74, v76
    v_swap_b32 v75, v77
    v_xor_b32 v48, 0x80000000, v48
    v_xor_b32 v49, 0x80000000, v49
    v_xor_b32 v50, 0x80000000, v50
    v_xor_b32 v51, 0x80000000, v51
    v_xor_b32 v52, 0x80000000, v52
    v_xor_b32 v53, 0x80000000, v53
    v_xor_b32 v54, 0x80000000, v54
    v_xor_b32 v55, 0x80000000, v55
    v_xor_b32 v56, 0x80000000, v56
    v_xor_b32 v57, 0x80000000, v57
    v_xor_b32 v58, 0x80000000, v58
    v_xor_b32 v59, 0x80000000, v59
    v_xor_b32 v60, 0x80000000, v60
    v_xor_b32 v61, 0x80000000, v61
    v_xor_b32 v62, 0x80000000, v62
    v_xor_b32 v63, 0x80000000, v63
    v_xor_b32 v64, 0x80000000, v64
    v_xor_b32 v65, 0x80000000, v65
    v_xor_b32 v66, 0x80000000, v66
    v_xor_b32 v67, 0x80000000, v67
    v_xor_b32 v68, 0x80000000, v68
    v_xor_b32 v69, 0x80000000, v69
    v_xor_b32 v70, 0x80000000, v70
    v_xor_b32 v71, 0x80000000, v71
    v_xor_b32 v72, 0x80000000, v72
    v_xor_b32 v73, 0x80000000, v73
    v_xor_b32 v74, 0x80000000, v74
    v_xor_b32 v75, 0x80000000, v75
    v_xor_b32 v76, 0x80000000, v76
    v_xor_b32 v77, 0x80000000, v77
    v_xor_b32 v78, 0x80000000, v78
    v_xor_b32 v79, 0x80000000, v79
    s_nop 1
    v_mfma_f32_16x16x32_bf16 v[116:119], v[48:51], v[136:139], 0
    v_mfma_f32_16x16x32_bf16 v[112:115], v[52:55], v[136:139], 0
    v_mfma_f32_16x16x32_bf16 v[116:119], v[56:59], v[140:143], v[116:119]
    v_mfma_f32_16x16x32_bf16 v[112:115], v[60:63], v[140:143], v[112:115]
    v_mfma_f32_16x16x32_bf16 v[116:119], v[64:67], v[144:147], v[116:119]
    v_mfma_f32_16x16x32_bf16 v[112:115], v[68:71], v[144:147], v[112:115]
    v_mfma_f32_16x16x32_bf16 v[116:119], v[72:75], v[148:151], v[116:119]
    v_mfma_f32_16x16x32_bf16 v[112:115], v[76:79], v[148:151], v[112:115]
    s_waitcnt vmcnt(0)
    v_mfma_f32_16x16x32_bf16 v[120:123], v[200:203], v[80:83], 0
    v_mfma_f32_16x16x32_bf16 v[124:127], v[204:207], v[80:83], 0
    v_mfma_f32_16x16x32_bf16 v[120:123], v[200:203], v[84:87], v[120:123]
    v_mfma_f32_16x16x32_bf16 v[124:127], v[204:207], v[84:87], v[124:127]
    v_mfma_f32_16x16x32_bf16 v[120:123], v[200:203], v[88:91], v[120:123]
    v_mfma_f32_16x16x32_bf16 v[124:127], v[204:207], v[88:91], v[124:127]
    v_mfma_f32_16x16x32_bf16 v[120:123], v[200:203], v[92:95], v[120:123]
    v_mfma_f32_16x16x32_bf16 v[124:127], v[204:207], v[92:95], v[124:127]
    v_mfma_f32_16x16x32_bf16 v[120:123], v[200:203], v[96:99], v[120:123]
    v_mfma_f32_16x16x32_bf16 v[124:127], v[204:207], v[96:99], v[124:127]
    v_mfma_f32_16x16x32_bf16 v[120:123], v[200:203], v[100:103], v[120:123]
    v_mfma_f32_16x16x32_bf16 v[124:127], v[204:207], v[100:103], v[124:127]
    v_mfma_f32_16x16x32_bf16 v[120:123], v[200:203], v[104:107], v[120:123]
    v_mfma_f32_16x16x32_bf16 v[124:127], v[204:207], v[104:107], v[124:127]
    v_mfma_f32_16x16x32_bf16 v[120:123], v[200:203], v[108:111], v[120:123]
    v_mfma_f32_16x16x32_bf16 v[124:127], v[204:207], v[108:111], v[124:127]
    v_mul_f32 v112, v224, v112
    v_mul_f32 v113, v224, v113
    v_mul_f32 v114, v224, v114
    v_mul_f32 v115, v224, v115
    v_mul_f32 v116, v224, v116
    v_mul_f32 v117, v224, v117
    v_mul_f32 v118, v224, v118
    v_mul_f32 v119, v224, v119
    v_sub_f32 v14, 1.0, v224
    s_lshl_b32 s16, s55, 1
    v_fma_f32 v120, v14, v120, v112
    v_fma_f32 v121, v14, v121, v113
    v_fma_f32 v122, v14, v122, v114
    v_fma_f32 v123, v14, v123, v115
    v_fma_f32 v124, v14, v124, v116
    v_fma_f32 v125, v14, v125, v117
    v_fma_f32 v126, v14, v126, v118
    v_fma_f32 v127, v14, v127, v119
    v_cvt_pk_bf16_f32 v248, v120, v124
    v_cvt_pk_bf16_f32 v249, v121, v125
    v_cvt_pk_bf16_f32 v250, v122, v126
    v_cvt_pk_bf16_f32 v251, v123, v127
    buffer_store_dwordx4 v[248:251], v216, s[36:39], s16 offen
    s_branch AX_U2
AX_U:
    s_waitcnt vmcnt(0)
AX_U2:
    v_swap_b32 v18, v20
    v_swap_b32 v19, v21
    v_swap_b32 v26, v28
    v_swap_b32 v27, v29
    v_swap_b32 v34, v36
    v_swap_b32 v35, v37
    v_swap_b32 v42, v44
    v_swap_b32 v43, v45
    s_cmp_ge_u32 s54, 288
    s_cbranch_scc0 AX_U3
    v_xor_b32 v16, 0x80000000, v16
    v_xor_b32 v17, 0x80000000, v17
    v_xor_b32 v18, 0x80000000, v18
    v_xor_b32 v19, 0x80000000, v19
    v_xor_b32 v20, 0x80000000, v20
    v_xor_b32 v21, 0x80000000, v21
    v_xor_b32 v22, 0x80000000, v22
    v_xor_b32 v23, 0x80000000, v23
    v_xor_b32 v24, 0x80000000, v24
    v_xor_b32 v25, 0x80000000, v25
    v_xor_b32 v26, 0x80000000, v26
    v_xor_b32 v27, 0x80000000, v27
    v_xor_b32 v28, 0x80000000, v28
    v_xor_b32 v29, 0x80000000, v29
    v_xor_b32 v30, 0x80000000, v30
    v_xor_b32 v31, 0x80000000, v31
    v_xor_b32 v32, 0x80000000, v32
    v_xor_b32 v33, 0x80000000, v33
    v_xor_b32 v34, 0x80000000, v34
    v_xor_b32 v35, 0x80000000, v35
    v_xor_b32 v36, 0x80000000, v36
    v_xor_b32 v37, 0x80000000, v37
    v_xor_b32 v38, 0x80000000, v38
    v_xor_b32 v39, 0x80000000, v39
    v_xor_b32 v40, 0x80000000, v40
    v_xor_b32 v41, 0x80000000, v41
    v_xor_b32 v42, 0x80000000, v42
    v_xor_b32 v43, 0x80000000, v43
    v_xor_b32 v44, 0x80000000, v44
    v_xor_b32 v45, 0x80000000, v45
    v_xor_b32 v46, 0x80000000, v46
    v_xor_b32 v47, 0x80000000, v47
    v_swap_b32 v16, v20
    v_swap_b32 v17, v21
    v_swap_b32 v18, v22
    v_swap_b32 v19, v23
    v_swap_b32 v24, v28
    v_swap_b32 v25, v29
    v_swap_b32 v26, v30
    v_swap_b32 v27, v31
    v_swap_b32 v32, v36
    v_swap_b32 v33, v37
    v_swap_b32 v34, v38
    v_swap_b32 v35, v39
    v_swap_b32 v40, v44
    v_swap_b32 v41, v45
    v_swap_b32 v42, v46
    v_swap_b32 v43, v47
AX_U3:
    s_nop 1
    v_mfma_f32_16x16x32_bf16 v[80:83], v[16:19], v[136:139], 0
    v_mfma_f32_16x16x32_bf16 v[84:87], v[16:19], v[152:155], 0
    v_mfma_f32_16x16x32_bf16 v[88:91], v[16:19], v[168:171], 0
    v_mfma_f32_16x16x32_bf16 v[92:95], v[16:19], v[184:187], 0
    v_mfma_f32_16x16x32_bf16 v[96:99], v[20:23], v[136:139], 0
    v_mfma_f32_16x16x32_bf16 v[100:103], v[20:23], v[152:155], 0
    v_mfma_f32_16x16x32_bf16 v[104:107], v[20:23], v[168:171], 0
    v_mfma_f32_16x16x32_bf16 v[108:111], v[20:23], v[184:187], 0
    v_mfma_f32_16x16x32_bf16 v[80:83], v[24:27], v[140:143], v[80:83]
    v_mfma_f32_16x16x32_bf16 v[84:87], v[24:27], v[156:159], v[84:87]
    v_mfma_f32_16x16x32_bf16 v[88:91], v[24:27], v[172:175], v[88:91]
    v_mfma_f32_16x16x32_bf16 v[92:95], v[24:27], v[188:191], v[92:95]
    v_mfma_f32_16x16x32_bf16 v[96:99], v[28:31], v[140:143], v[96:99]
    v_mfma_f32_16x16x32_bf16 v[100:103], v[28:31], v[156:159], v[100:103]
    v_mfma_f32_16x16x32_bf16 v[104:107], v[28:31], v[172:175], v[104:107]
    v_mfma_f32_16x16x32_bf16 v[108:111], v[28:31], v[188:191], v[108:111]
    v_mfma_f32_16x16x32_bf16 v[80:83], v[32:35], v[144:147], v[80:83]
    v_mfma_f32_16x16x32_bf16 v[84:87], v[32:35], v[160:163], v[84:87]
    v_mfma_f32_16x16x32_bf16 v[88:91], v[32:35], v[176:179], v[88:91]
    v_mfma_f32_16x16x32_bf16 v[92:95], v[32:35], v[192:195], v[92:95]
    v_mfma_f32_16x16x32_bf16 v[96:99], v[36:39], v[144:147], v[96:99]
    v_mfma_f32_16x16x32_bf16 v[100:103], v[36:39], v[160:163], v[100:103]
    v_mfma_f32_16x16x32_bf16 v[104:107], v[36:39], v[176:179], v[104:107]
    v_mfma_f32_16x16x32_bf16 v[108:111], v[36:39], v[192:195], v[108:111]
    v_mfma_f32_16x16x32_bf16 v[80:83], v[40:43], v[148:151], v[80:83]
    v_mfma_f32_16x16x32_bf16 v[84:87], v[40:43], v[164:167], v[84:87]
    v_mfma_f32_16x16x32_bf16 v[88:91], v[40:43], v[180:183], v[88:91]
    v_mfma_f32_16x16x32_bf16 v[92:95], v[40:43], v[196:199], v[92:95]
    v_mfma_f32_16x16x32_bf16 v[96:99], v[44:47], v[148:151], v[96:99]
    v_mfma_f32_16x16x32_bf16 v[100:103], v[44:47], v[164:167], v[100:103]
    v_mfma_f32_16x16x32_bf16 v[104:107], v[44:47], v[180:183], v[104:107]
    v_mfma_f32_16x16x32_bf16 v[108:111], v[44:47], v[196:199], v[108:111]
    s_mul_i32 s18, s4, 589824
    s_lshl_b32 s17, s15, 13
    s_add_u32 s18, s18, s17
    s_add_u32 s18, s18, s44
    s_mov_b32 s66, 0
    s_sub_u32 s48, s3, 7
    s_and_b32 s48, s48, 7
    s_lshl_b32 s49, s48, 1
    s_lshl_b32 s49, 3, s49
    s_mul_i32 s48, s48, 73728
    s_add_u32 s48, s48, s18
    s_add_u32 s16, s44, 147456
    v_add_u32 v128, s16, v220
    v_add_u32 v129, s16, v221
    v_add_u32 v130, s16, v222
    v_add_u32 v131, s16, v223
    s_sub_u32 s16, s3, 1
    s_and_b32 s16, s16, 7
    s_lshl_b32 s17, s16, 1
    s_lshl_b32 s17, 3, s17
    s_mul_i32 s16, s16, 73728
    s_add_u32 s16, s16, s18
    s_and_b32 s19, s66, s17
    s_cmp_eq_u32 s19, s17
    s_cbranch_scc1 AX_G1
PC5:
    s_sleep 3
    ds_read_b32 v5, v15
    s_add_u32 s99, s99, 1
    s_cmp_gt_u32 s99, 0x100000
    s_cbranch_scc1 K_END
    s_waitcnt lgkmcnt(0)
    v_cmp_gt_u32 vcc, 28, v5
    s_cbranch_vccnz PC5
    s_branch AX_F1
AX_R1:
    s_sleep 12
AX_F1:
    buffer_load_dword v5, v229, s[32:35], s65 offen sc1
    s_add_u32 s47, s47, 1
    s_waitcnt vmcnt(0)
    v_cmp_le_u32 vcc, v254, v5
    s_cmp_gt_u32 s47, 32768
    s_cbranch_scc1 AX_G1
    s_mov_b32 s66, vcc_lo
    s_mov_b32 exec_lo, s17
    s_mov_b32 exec_hi, 0
    s_and_b32 s19, s66, s17
    s_cmp_eq_u32 s19, s17
    s_cbranch_scc0 AX_R1
AX_G1:
    s_mov_b64 exec, -1
    buffer_load_dwordx4 v[32:35], v220, s[32:35], s16 offen sc1
    buffer_load_dwordx4 v[36:39], v221, s[32:35], s16 offen sc1
    buffer_load_dwordx4 v[40:43], v222, s[32:35], s16 offen sc1
    buffer_load_dwordx4 v[44:47], v223, s[32:35], s16 offen sc1
    v_mul_f32 v80, v224, v80
    v_mul_f32 v81, v224, v81
    v_mul_f32 v82, v224, v82
    v_mul_f32 v83, v224, v83
    v_mul_f32 v96, v224, v96
    v_mul_f32 v97, v224, v97
    v_mul_f32 v98, v224, v98
    v_mul_f32 v99, v224, v99
    v_sub_f32 v224, 1.0, v224
    v_mul_f32 v84, v225, v84
    v_mul_f32 v85, v225, v85
    v_mul_f32 v86, v225, v86
    v_mul_f32 v87, v225, v87
    v_mul_f32 v100, v225, v100
    v_mul_f32 v101, v225, v101
    v_mul_f32 v102, v225, v102
    v_mul_f32 v103, v225, v103
    v_sub_f32 v225, 1.0, v225
    v_mul_f32 v88, v226, v88
    v_mul_f32 v89, v226, v89
    v_mul_f32 v90, v226, v90
    v_mul_f32 v91, v226, v91
    v_mul_f32 v104, v226, v104
    v_mul_f32 v105, v226, v105
    v_mul_f32 v106, v226, v106
    v_mul_f32 v107, v226, v107
    v_sub_f32 v226, 1.0, v226
    v_mul_f32 v92, v227, v92
    v_mul_f32 v93, v227, v93
    v_mul_f32 v94, v227, v94
    v_mul_f32 v95, v227, v95
    v_mul_f32 v108, v227, v108
    v_mul_f32 v109, v227, v109
    v_mul_f32 v110, v227, v110
    v_mul_f32 v111, v227, v111
    v_sub_f32 v227, 1.0, v227
    s_sub_u32 s16, s3, 2
    s_and_b32 s16, s16, 7
    s_lshl_b32 s17, s16, 1
    s_lshl_b32 s17, 3, s17
    s_mul_i32 s16, s16, 73728
    s_add_u32 s16, s16, s18
    s_and_b32 s19, s66, s17
    s_cmp_eq_u32 s19, s17
    s_cbranch_scc1 AX_G2
PC6:
    s_sleep 3
    ds_read_b32 v5, v15
    s_add_u32 s99, s99, 1
    s_cmp_gt_u32 s99, 0x100000
    s_cbranch_scc1 K_END
    s_waitcnt lgkmcnt(0)
    v_cmp_gt_u32 vcc, 35, v5
    s_cbranch_vccnz PC6
    s_branch AX_F2
AX_R2:
    s_sleep 12
AX_F2:
    buffer_load_dword v5, v229, s[32:35], s65 offen sc1
    s_add_u32 s47, s47, 1
    s_waitcnt vmcnt(0)
    v_cmp_le_u32 vcc, v254, v5
    s_cmp_gt_u32 s47, 32768
    s_cbranch_scc1 AX_G2
    s_mov_b32 s66, vcc_lo
    s_mov_b32 exec_lo, s17
    s_mov_b32 exec_hi, 0
    s_and_b32 s19, s66, s17
    s_cmp_eq_u32 s19, s17
    s_cbranch_scc0 AX_R2
AX_G2:
    s_mov_b64 exec, -1
    buffer_load_dwordx4 v[48:51], v220, s[32:35], s16 offen sc1
    buffer_load_dwordx4 v[52:55], v221, s[32:35], s16 offen sc1
    buffer_load_dwordx4 v[56:59], v222, s[32:35], s16 offen sc1
    buffer_load_dwordx4 v[60:63], v223, s[32:35], s16 offen sc1
    s_sub_u32 s16, s3, 3
    s_and_b32 s16, s16, 7
    s_lshl_b32 s17, s16, 1
    s_lshl_b32 s17, 3, s17
    s_mul_i32 s16, s16, 73728
    s_add_u32 s16, s16, s18
    s_and_b32 s19, s66, s17
    s_cmp_eq_u32 s19, s17
    s_cbranch_scc1 AX_G3
PC7:
    s_sleep 3
    ds_read_b32 v5, v15
    s_add_u32 s99, s99, 1
    s_cmp_gt_u32 s99, 0x100000
    s_cbranch_scc1 K_END
    s_waitcnt lgkmcnt(0)
    v_cmp_gt_u32 vcc, 35, v5
    s_cbranch_vccnz PC7
    s_branch AX_F3
AX_R3:
    s_sleep 12
AX_F3:
    buffer_load_dword v5, v229, s[32:35], s65 offen sc1
    s_add_u32 s47, s47, 1
    s_waitcnt vmcnt(0)
    v_cmp_le_u32 vcc, v254, v5
    s_cmp_gt_u32 s47, 32768
    s_cbranch_scc1 AX_G3
    s_mov_b32 s66, vcc_lo
    s_mov_b32 exec_lo, s17
    s_mov_b32 exec_hi, 0
    s_and_b32 s19, s66, s17
    s_cmp_eq_u32 s19, s17
    s_cbranch_scc0 AX_R3
AX_G3:
    s_mov_b64 exec, -1
    buffer_load_dwordx4 v[64:67], v220, s[32:35], s16 offen sc1
    buffer_load_dwordx4 v[68:71], v221, s[32:35], s16 offen sc1
    buffer_load_dwordx4 v[72:75], v222, s[32:35], s16 offen sc1
    buffer_load_dwordx4 v[76:79], v223, s[32:35], s16 offen sc1
    s_waitcnt vmcnt(8)
    v_mfma_f32_16x16x32_bf16 v[152:155], v[200:203], v[32:35], 0
    v_mfma_f32_16x16x32_bf16 v[168:171], v[204:207], v[32:35], 0
    v_mfma_f32_16x16x32_bf16 v[156:159], v[200:203], v[36:39], 0
    v_mfma_f32_16x16x32_bf16 v[172:175], v[204:207], v[36:39], 0
    v_mfma_f32_16x16x32_bf16 v[160:163], v[200:203], v[40:43], 0
    v_mfma_f32_16x16x32_bf16 v[176:179], v[204:207], v[40:43], 0
    v_mfma_f32_16x16x32_bf16 v[164:167], v[200:203], v[44:47], 0
    v_mfma_f32_16x16x32_bf16 v[180:183], v[204:207], v[44:47], 0
    s_sub_u32 s16, s3, 4
    s_and_b32 s16, s16, 7
    s_lshl_b32 s17, s16, 1
    s_lshl_b32 s17, 3, s17
    s_mul_i32 s16, s16, 73728
    s_add_u32 s16, s16, s18
    s_and_b32 s19, s66, s17
    s_cmp_eq_u32 s19, s17
    s_cbranch_scc1 AX_G4
PC8:
    s_sleep 3
    ds_read_b32 v5, v15
    s_add_u32 s99, s99, 1
    s_cmp_gt_u32 s99, 0x100000
    s_cbranch_scc1 K_END
    s_waitcnt lgkmcnt(0)
    v_cmp_gt_u32 vcc, 35, v5
    s_cbranch_vccnz PC8
    s_branch AX_F4
AX_R4:
    s_sleep 12
AX_F4:
    buffer_load_dword v5, v229, s[32:35], s65 offen sc1
    s_add_u32 s47, s47, 1
    s_waitcnt vmcnt(0)
    v_cmp_le_u32 vcc, v254, v5
    s_cmp_gt_u32 s47, 32768
    s_cbranch_scc1 AX_G4
    s_mov_b32 s66, vcc_lo
    s_mov_b32 exec_lo, s17
    s_mov_b32 exec_hi, 0
    s_and_b32 s19, s66, s17
    s_cmp_eq_u32 s19, s17
    s_cbranch_scc0 AX_R4
AX_G4:
    s_mov_b64 exec, -1
    buffer_load_dwordx4 v[16:19], v220, s[32:35], s16 offen sc1
    buffer_load_dwordx4 v[20:23], v221, s[32:35], s16 offen sc1
    buffer_load_dwordx4 v[24:27], v222, s[32:35], s16 offen sc1
    buffer_load_dwordx4 v[28:31], v223, s[32:35], s16 offen sc1
    s_waitcnt vmcnt(8)
    v_mfma_f32_16x16x32_bf16 v[152:155], v[200:203], v[48:51], v[152:155]
    v_mfma_f32_16x16x32_bf16 v[168:171], v[204:207], v[48:51], v[168:171]
    v_mfma_f32_16x16x32_bf16 v[156:159], v[200:203], v[52:55], v[156:159]
    v_mfma_f32_16x16x32_bf16 v[172:175], v[204:207], v[52:55], v[172:175]
    v_mfma_f32_16x16x32_bf16 v[160:163], v[200:203], v[56:59], v[160:163]
    v_mfma_f32_16x16x32_bf16 v[176:179], v[204:207], v[56:59], v[176:179]
    v_mfma_f32_16x16x32_bf16 v[164:167], v[200:203], v[60:63], v[164:167]
    v_mfma_f32_16x16x32_bf16 v[180:183], v[204:207], v[60:63], v[180:183]
    s_sub_u32 s16, s3, 5
    s_and_b32 s16, s16, 7
    s_lshl_b32 s17, s16, 1
    s_lshl_b32 s17, 3, s17
    s_mul_i32 s16, s16, 73728
    s_add_u32 s16, s16, s18
    s_and_b32 s19, s66, s17
    s_cmp_eq_u32 s19, s17
    s_cbranch_scc1 AX_G5
PC9:
    s_sleep 3
    ds_read_b32 v5, v15
    s_add_u32 s99, s99, 1
    s_cmp_gt_u32 s99, 0x100000
    s_cbranch_scc1 K_END
    s_waitcnt lgkmcnt(0)
    v_cmp_gt_u32 vcc, 36, v5
    s_cbranch_vccnz PC9
    s_branch AX_F5
AX_R5:
    s_sleep 12
AX_F5:
    buffer_load_dword v5, v229, s[32:35], s65 offen sc1
    s_add_u32 s47, s47, 1
    s_waitcnt vmcnt(0)
    v_cmp_le_u32 vcc, v254, v5
    s_cmp_gt_u32 s47, 32768
    s_cbranch_scc1 AX_G5
    s_mov_b32 s66, vcc_lo
    s_mov_b32 exec_lo, s17
    s_mov_b32 exec_hi, 0
    s_and_b32 s19, s66, s17
    s_cmp_eq_u32 s19, s17
    s_cbranch_scc0 AX_R5
AX_G5:
    s_mov_b64 exec, -1
    buffer_load_dwordx4 v[32:35], v220, s[32:35], s16 offen sc1
    buffer_load_dwordx4 v[36:39], v221, s[32:35], s16 offen sc1
    buffer_load_dwordx4 v[40:43], v222, s[32:35], s16 offen sc1
    buffer_load_dwordx4 v[44:47], v223, s[32:35], s16 offen sc1
    s_waitcnt vmcnt(8)
    v_mfma_f32_16x16x32_bf16 v[152:155], v[200:203], v[64:67], v[152:155]
    v_mfma_f32_16x16x32_bf16 v[168:171], v[204:207], v[64:67], v[168:171]
    v_mfma_f32_16x16x32_bf16 v[156:159], v[200:203], v[68:71], v[156:159]
    v_mfma_f32_16x16x32_bf16 v[172:175], v[204:207], v[68:71], v[172:175]
    v_mfma_f32_16x16x32_bf16 v[160:163], v[200:203], v[72:75], v[160:163]
    v_mfma_f32_16x16x32_bf16 v[176:179], v[204:207], v[72:75], v[176:179]
    v_mfma_f32_16x16x32_bf16 v[164:167], v[200:203], v[76:79], v[164:167]
    v_mfma_f32_16x16x32_bf16 v[180:183], v[204:207], v[76:79], v[180:183]
    s_sub_u32 s16, s3, 6
    s_and_b32 s16, s16, 7
    s_lshl_b32 s17, s16, 1
    s_lshl_b32 s17, 3, s17
    s_mul_i32 s16, s16, 73728
    s_add_u32 s16, s16, s18
    s_and_b32 s19, s66, s17
    s_cmp_eq_u32 s19, s17
    s_cbranch_scc1 AX_G6
PC10:
    s_sleep 3
    ds_read_b32 v5, v15
    s_add_u32 s99, s99, 1
    s_cmp_gt_u32 s99, 0x100000
    s_cbranch_scc1 K_END
    s_waitcnt lgkmcnt(0)
    v_cmp_gt_u32 vcc, 38, v5
    s_cbranch_vccnz PC10
    s_or_b32 s50, s17, s49
    s_mov_b32 exec_lo, s50
    s_mov_b32 exec_hi, 0
    s_branch AX_F6
AX_R6:
AX_F6:
    buffer_load_dword v5, v229, s[32:35], s65 offen sc1
    s_add_u32 s47, s47, 1
    s_waitcnt vmcnt(0)
    v_cmp_le_u32 vcc, v254, v5
    s_cmp_gt_u32 s47, 32768
    s_cbranch_scc1 AX_G6
    s_mov_b32 s66, vcc_lo
    s_mov_b32 exec_lo, s50
    s_mov_b32 exec_hi, 0
    s_and_b32 s19, s66, s17
    s_cmp_eq_u32 s19, s17
    s_cbranch_scc0 AX_R6
AX_G6:
    s_mov_b64 exec, -1
    buffer_load_dwordx4 v[48:51], v220, s[32:35], s16 offen sc1
    buffer_load_dwordx4 v[52:55], v221, s[32:35], s16 offen sc1
    buffer_load_dwordx4 v[56:59], v222, s[32:35], s16 offen sc1
    buffer_load_dwordx4 v[60:63], v223, s[32:35], s16 offen sc1
    s_waitcnt vmcnt(8)
    v_mfma_f32_16x16x32_bf16 v[152:155], v[200:203], v[16:19], v[152:155]
    v_mfma_f32_16x16x32_bf16 v[168:171], v[204:207], v[16:19], v[168:171]
    v_mfma_f32_16x16x32_bf16 v[156:159], v[200:203], v[20:23], v[156:159]
    v_mfma_f32_16x16x32_bf16 v[172:175], v[204:207], v[20:23], v[172:175]
    v_mfma_f32_16x16x32_bf16 v[160:163], v[200:203], v[24:27], v[160:163]
    v_mfma_f32_16x16x32_bf16 v[176:179], v[204:207], v[24:27], v[176:179]
    v_mfma_f32_16x16x32_bf16 v[164:167], v[200:203], v[28:31], v[164:167]
    v_mfma_f32_16x16x32_bf16 v[180:183], v[204:207], v[28:31], v[180:183]
    s_and_b32 s19, s66, s49
    s_cmp_eq_u32 s19, s49
    s_cbranch_scc1 AX_G7
    s_mov_b32 exec_lo, s49
    s_mov_b32 exec_hi, 0
    s_branch AX_F7
AX_R7:
AX_F7:
    buffer_load_dword v5, v229, s[32:35], s65 offen sc1
    s_add_u32 s47, s47, 1
    s_waitcnt vmcnt(0)
    v_cmp_le_u32 vcc, v254, v5
    s_cmp_gt_u32 s47, 32768
    s_cbranch_scc1 AX_G7
    s_mov_b32 s66, vcc_lo
    s_mov_b32 exec_lo, s49
    s_mov_b32 exec_hi, 0
    s_and_b32 s19, s66, s49
    s_cmp_eq_u32 s19, s49
    s_cbranch_scc0 AX_R7
AX_G7:
    s_mov_b64 exec, -1
    buffer_load_dwordx4 v[64:67], v220, s[32:35], s48 offen sc1
    buffer_load_dwordx4 v[68:71], v221, s[32:35], s48 offen sc1
    buffer_load_dwordx4 v[72:75], v222, s[32:35], s48 offen sc1
    buffer_load_dwordx4 v[76:79], v223, s[32:35], s48 offen sc1
    s_waitcnt vmcnt(8)
    v_mfma_f32_16x16x32_bf16 v[152:155], v[200:203], v[32:35], v[152:155]
    v_mfma_f32_16x16x32_bf16 v[168:171], v[204:207], v[32:35], v[168:171]
    v_mfma_f32_16x16x32_bf16 v[156:159], v[200:203], v[36:39], v[156:159]
    v_mfma_f32_16x16x32_bf16 v[172:175], v[204:207], v[36:39], v[172:175]
    v_mfma_f32_16x16x32_bf16 v[160:163], v[200:203], v[40:43], v[160:163]
    v_mfma_f32_16x16x32_bf16 v[176:179], v[204:207], v[40:43], v[176:179]
    v_mfma_f32_16x16x32_bf16 v[164:167], v[200:203], v[44:47], v[164:167]
    v_mfma_f32_16x16x32_bf16 v[180:183], v[204:207], v[44:47], v[180:183]
W11:
    ds_read_b32 v5, v15
    s_add_u32 s99, s99, 1
    s_cmp_gt_u32 s99, 0x100000
    s_cbranch_scc1 K_END
    s_waitcnt lgkmcnt(0)
    v_cmp_gt_u32 vcc, 39, v5
    s_cbranch_vccnz W11
    ds_read_b128 v[16:19], v128
    ds_read_b128 v[20:23], v129
    ds_read_b128 v[24:27], v130
    ds_read_b128 v[28:31], v131
    s_waitcnt lgkmcnt(0)
    v_mfma_f32_16x16x32_bf16 v[152:155], v[200:203], v[16:19], v[152:155]
    v_mfma_f32_16x16x32_bf16 v[168:171], v[204:207], v[16:19], v[168:171]
    v_mfma_f32_16x16x32_bf16 v[156:159], v[200:203], v[20:23], v[156:159]
    v_mfma_f32_16x16x32_bf16 v[172:175], v[204:207], v[20:23], v[172:175]
    v_mfma_f32_16x16x32_bf16 v[160:163], v[200:203], v[24:27], v[160:163]
    v_mfma_f32_16x16x32_bf16 v[176:179], v[204:207], v[24:27], v[176:179]
    v_mfma_f32_16x16x32_bf16 v[164:167], v[200:203], v[28:31], v[164:167]
    v_mfma_f32_16x16x32_bf16 v[180:183], v[204:207], v[28:31], v[180:183]
    s_waitcnt vmcnt(4)
    v_mfma_f32_16x16x32_bf16 v[152:155], v[200:203], v[48:51], v[152:155]
    v_mfma_f32_16x16x32_bf16 v[168:171], v[204:207], v[48:51], v[168:171]
    v_mfma_f32_16x16x32_bf16 v[156:159], v[200:203], v[52:55], v[156:159]
    v_mfma_f32_16x16x32_bf16 v[172:175], v[204:207], v[52:55], v[172:175]
    v_mfma_f32_16x16x32_bf16 v[160:163], v[200:203], v[56:59], v[160:163]
    v_mfma_f32_16x16x32_bf16 v[176:179], v[204:207], v[56:59], v[176:179]
    v_mfma_f32_16x16x32_bf16 v[164:167], v[200:203], v[60:63], v[164:167]
    v_mfma_f32_16x16x32_bf16 v[180:183], v[204:207], v[60:63], v[180:183]
    s_lshl_b32 s16, s54, 1
    s_waitcnt vmcnt(3)
    v_mfma_f32_16x16x32_bf16 v[152:155], v[200:203], v[64:67], v[152:155]
    v_mfma_f32_16x16x32_bf16 v[168:171], v[204:207], v[64:67], v[168:171]
    s_waitcnt vmcnt(2)
    v_mfma_f32_16x16x32_bf16 v[156:159], v[200:203], v[68:71], v[156:159]
    v_mfma_f32_16x16x32_bf16 v[172:175], v[204:207], v[68:71], v[172:175]
    s_waitcnt vmcnt(1)
    v_mfma_f32_16x16x32_bf16 v[160:163], v[200:203], v[72:75], v[160:163]
    v_mfma_f32_16x16x32_bf16 v[176:179], v[204:207], v[72:75], v[176:179]
    s_waitcnt vmcnt(0)
    v_mfma_f32_16x16x32_bf16 v[164:167], v[200:203], v[76:79], v[164:167]
    v_mfma_f32_16x16x32_bf16 v[180:183], v[204:207], v[76:79], v[180:183]
    s_nop 3
    v_fma_f32 v152, v224, v152, v80
    v_fma_f32 v153, v224, v153, v81
    v_fma_f32 v154, v224, v154, v82
    v_fma_f32 v155, v224, v155, v83
    v_fma_f32 v168, v224, v168, v96
    v_fma_f32 v169, v224, v169, v97
    v_fma_f32 v170, v224, v170, v98
    v_fma_f32 v171, v224, v171, v99
    v_cvt_pk_bf16_f32 v232, v152, v168
    v_cvt_pk_bf16_f32 v233, v153, v169
    v_cvt_pk_bf16_f32 v234, v154, v170
    v_cvt_pk_bf16_f32 v235, v155, v171
    buffer_store_dwordx4 v[232:235], v216, s[36:39], s16 offen
    v_fma_f32 v156, v225, v156, v84
    v_fma_f32 v157, v225, v157, v85
    v_fma_f32 v158, v225, v158, v86
    v_fma_f32 v159, v225, v159, v87
    v_fma_f32 v172, v225, v172, v100
    v_fma_f32 v173, v225, v173, v101
    v_fma_f32 v174, v225, v174, v102
    v_fma_f32 v175, v225, v175, v103
    v_cvt_pk_bf16_f32 v236, v156, v172
    v_cvt_pk_bf16_f32 v237, v157, v173
    v_cvt_pk_bf16_f32 v238, v158, v174
    v_cvt_pk_bf16_f32 v239, v159, v175
    buffer_store_dwordx4 v[236:239], v217, s[36:39], s16 offen
    v_fma_f32 v160, v226, v160, v88
    v_fma_f32 v161, v226, v161, v89
    v_fma_f32 v162, v226, v162, v90
    v_fma_f32 v163, v226, v163, v91
    v_fma_f32 v176, v226, v176, v104
    v_fma_f32 v177, v226, v177, v105
    v_fma_f32 v178, v226, v178, v106
    v_fma_f32 v179, v226, v179, v107
    v_cvt_pk_bf16_f32 v240, v160, v176
    v_cvt_pk_bf16_f32 v241, v161, v177
    v_cvt_pk_bf16_f32 v242, v162, v178
    v_cvt_pk_bf16_f32 v243, v163, v179
    buffer_store_dwordx4 v[240:243], v218, s[36:39], s16 offen
    v_fma_f32 v164, v227, v164, v92
    v_fma_f32 v165, v227, v165, v93
    v_fma_f32 v166, v227, v166, v94
    v_fma_f32 v167, v227, v167, v95
    v_fma_f32 v180, v227, v180, v108
    v_fma_f32 v181, v227, v181, v109
    v_fma_f32 v182, v227, v182, v110
    v_fma_f32 v183, v227, v183, v111
    v_cvt_pk_bf16_f32 v244, v164, v180
    v_cvt_pk_bf16_f32 v245, v165, v181
    v_cvt_pk_bf16_f32 v246, v166, v182
    v_cvt_pk_bf16_f32 v247, v167, v183
    buffer_store_dwordx4 v[244:247], v219, s[36:39], s16 offen
    s_endpgm
K_END:
    s_endpgm
.section .rodata,"a"
.p2align 6
.amdhsa_kernel gated_mix__spectral_fnet__dense_activation_relu__prompt_kernel
  .amdhsa_next_free_vgpr 256
  .amdhsa_next_free_sgpr 100
  .amdhsa_accum_offset 256
  .amdhsa_group_segment_fixed_size 0
  .amdhsa_kernarg_size 96
  .amdhsa_user_sgpr_count 2
  .amdhsa_user_sgpr_kernarg_segment_ptr 1
  .amdhsa_system_sgpr_workgroup_id_x 1
.end_amdhsa_kernel
```
